```python
import torch

def _softmax(x, axis=-1):
    return torch.softmax(x, dim=axis)
def _gelu(x):
    return torch.nn.functional.gelu(x, approximate="tanh")
def _silu(x):
    return torch.nn.functional.silu(x)
def _sigmoid(x):
    return torch.sigmoid(x)
def _layernorm(x, axis=-1, eps=1e-5):
    m = x.mean(dim=axis, keepdim=True)
    v = x.var(dim=axis, keepdim=True, unbiased=False)
    return (x - m) / torch.sqrt(v + eps)
def _scatter_add(tgt, idx, src, axis=0):
    return tgt.clone().index_add_(axis, idx, src)
def _segment_sum(src, seg, n):
    out = torch.zeros((n,) + src.shape[1:], dtype=src.dtype)
    return out.index_add_(0, seg, src)
def _pad(x, pw):
    flat = tuple(v for pair in reversed(pw) for v in pair)
    return torch.nn.functional.pad(x, flat)

kernel_name = 'recurrent_scan__mha_block_cached__geglu_ffn__decode'

def setup_inputs():

    _w = (lambda a: (lambda t: t.to(torch.bfloat16) if t.is_floating_point() else t)(torch.as_tensor(a)))
    def _A_setup():
        B, Sq, D = 8, 1, 448
        H, Sk, Dh = 16, 4096, 256
        return {
            "x": _w((lambda *s: torch.randn(*s, dtype=torch.bfloat16) * 0.05)(B, Sq, D)),
            "k_cache": _w((lambda *s: torch.randn(*s, dtype=torch.bfloat16) * 1.6)(B, H, Sk, Dh)),
            "v_cache": _w((lambda *s: torch.randn(*s, dtype=torch.bfloat16) * 0.2)(B, H, Sk, Dh)),
            "wq": _w((lambda *s: torch.randn(*s, dtype=torch.bfloat16) * 1.6)(D, H * Dh) * (D ** -0.5)),
            "wo": _w((lambda *s: torch.randn(*s, dtype=torch.bfloat16) * 0.2)(H * Dh, D) * ((H * Dh) ** -0.5)),
        }
    _A_in = _A_setup()

    def _B_setup():
        B, S, D, F = 8, 1, 448, 1792
        return {
            "x": _w((lambda *s: torch.randn(*s, dtype=torch.bfloat16) * 0.05)(B, S, D)),
            "w_gate": _w((lambda *s: torch.randn(*s, dtype=torch.bfloat16) * 0.1)(D, F)),
            "w_up": _w((lambda *s: torch.randn(*s, dtype=torch.bfloat16) * 0.1)(D, F)),
            "w_down": _w((lambda *s: torch.randn(*s, dtype=torch.bfloat16) * 0.1)(F, D)),
        }
    _B_in = _B_setup()

    return {
        "A_x": _A_in["x"],
        "A_k_cache": _A_in["k_cache"],
        "A_v_cache": _A_in["v_cache"],
        "A_wq": _A_in["wq"],
        "A_wo": _A_in["wo"],
        "B_x": _B_in["x"],
        "B_w_gate": _B_in["w_gate"],
        "B_w_up": _B_in["w_up"],
        "B_w_down": _B_in["w_down"],
    }

def reference(A_x, A_k_cache, A_v_cache, A_wq, A_wo, B_x, B_w_gate, B_w_up, B_w_down):
    def _A_ref(x, k_cache, v_cache, wq, wo):
        B, Sq, D = x.shape
        H, Dh = 16, 256
        q = (lambda x, *d: x.permute(*d))((x @ wq).reshape(B, Sq, H, Dh), 0, 2, 1, 3)
        scores = torch.einsum("bhqd,bhkd->bhqk", q, k_cache) * (Dh ** -0.5)
        p = _softmax(scores, axis=-1)
        o = torch.einsum("bhqk,bhkd->bhqd", p, v_cache)
        return (lambda x, *d: x.permute(*d))(o, 0, 2, 1, 3).reshape(B, Sq, H * Dh) @ wo

    def _B_ref(x, w_gate, w_up, w_down):
        return (_gelu(x @ w_gate) * (x @ w_up)) @ w_down

    x = A_x
    xn = _layernorm(x, axis=-1)
    s = _A_ref(xn, A_k_cache, A_v_cache, A_wq, A_wo)
    g = _silu(_B_ref(xn, B_w_gate, B_w_up, B_w_down))
    return x + s * g
```

```asm
; @launch grid=(256,1,1) block=(576,1,1) lds=160256
.amdgcn_target "amdgcn-amd-amdhsa--gfx950"
.text
.globl recurrent_scan__mha_block_cached__geglu_ffn__decode_kernel
.p2align 8
.type recurrent_scan__mha_block_cached__geglu_ffn__decode_kernel,@function
recurrent_scan__mha_block_cached__geglu_ffn__decode_kernel:
    s_cmp_ge_u32 s2, 256
    s_cbranch_scc1 L_end
    s_load_dwordx4 s[36:39], s[0:1], 8
    s_load_dwordx2 s[32:33], s[0:1], 0
    s_load_dwordx4 s[40:43], s[0:1], 24
    s_load_dwordx8 s[44:51], s[0:1], 48
    s_load_dwordx4 s[52:55], s[0:1], 80
    v_lshrrev_b32 v1, 6, v0
    v_and_b32 v0, 63, v0
    v_readfirstlane_b32 s3, v1
    s_and_b32 s6, s2, 7
    s_lshl_b32 s6, s6, 2
    s_lshr_b32 s7, s2, 6
    s_add_u32 s6, s6, s7
    s_bfe_u32 s5, s2, 0x30003
    s_lshl_b32 s7, s5, 5
    s_add_u32 s7, s7, s6
    s_cmp_lg_u32 s3, 0
    s_cbranch_scc1 L_worker
    s_setprio 3
    v_lshlrev_b32 v8, 2, v0
    v_add_u32 v8, 151552, v8
    v_mov_b32 v1, 0
    ds_write_b32 v8, v1 offset:0
    ds_write_b32 v8, v1 offset:256
    v_and_b32 v9, 7, v0
    v_lshlrev_b32 v9, 2, v9
    v_add_u32 v9, 151552, v9
    v_lshrrev_b32 v1, 5, v0
    v_lshlrev_b32 v2, 4, v0
    v_lshlrev_b32 v1, 5, v1
    v_xor_b32 v4, v2, v1
    v_xor_b32 v5, 64, v4
    v_xor_b32 v6, 0x80, v4
    v_xor_b32 v7, 0xc0, v4
    s_lshl_b32 s24, s7, 20
    s_waitcnt lgkmcnt(0)
    s_add_u32 s8, s36, s24
    s_addc_u32 s9, s37, 0
    s_mov_b32 s10, 0x100000
    s_mov_b32 s11, 0x20000
    s_add_u32 s12, s38, s24
    s_addc_u32 s13, s39, 0
    s_mul_i32 s26, s2, 1
    s_lshl_b32 s26, s26, 14
    s_mov_b32 m0, 0
    s_and_b32 s26, s26, 0xfffff
    buffer_load_dwordx4 v4, s[8:11], s26 offen offset:0 nt lds
    buffer_load_dwordx4 v5, s[8:11], s26 offen offset:1024 nt lds
    buffer_load_dwordx4 v6, s[8:11], s26 offen offset:2048 nt lds
    buffer_load_dwordx4 v7, s[8:11], s26 offen offset:3072 nt lds
    s_barrier
    s_add_u32 s26, s26, 4096
    s_mov_b32 m0, 4096
    s_and_b32 s26, s26, 0xfffff
    buffer_load_dwordx4 v4, s[8:11], s26 offen offset:0 nt lds
    buffer_load_dwordx4 v5, s[8:11], s26 offen offset:1024 nt lds
    buffer_load_dwordx4 v6, s[8:11], s26 offen offset:2048 nt lds
    buffer_load_dwordx4 v7, s[8:11], s26 offen offset:3072 nt lds
    s_add_u32 s26, s26, 4096
    s_mov_b32 m0, 8192
    s_and_b32 s26, s26, 0xfffff
    buffer_load_dwordx4 v4, s[8:11], s26 offen offset:0 nt lds
    buffer_load_dwordx4 v5, s[8:11], s26 offen offset:1024 nt lds
    buffer_load_dwordx4 v6, s[8:11], s26 offen offset:2048 nt lds
    buffer_load_dwordx4 v7, s[8:11], s26 offen offset:3072 nt lds
    s_add_u32 s26, s26, 4096
    s_mov_b32 m0, 12288
    s_and_b32 s26, s26, 0xfffff
    buffer_load_dwordx4 v4, s[8:11], s26 offen offset:0 nt lds
    buffer_load_dwordx4 v5, s[8:11], s26 offen offset:1024 nt lds
    buffer_load_dwordx4 v6, s[8:11], s26 offen offset:2048 nt lds
    buffer_load_dwordx4 v7, s[8:11], s26 offen offset:3072 nt lds
    s_mov_b32 s25, 1
    s_mov_b32 s27, 16384
    s_mov_b32 s29, 0
    v_mov_b32 v10, 0
    s_mov_b32 s14, 369098752
    s_mov_b32 s15, 168296448
    s_lshr_b32 s24, s2, 5
    s_lshl_b32 s24, s24, 3
    s_lshr_b64 s[14:15], s[14:15], s24
    s_mov_b32 s16, 0
    s_mov_b32 s17, 0
    s_and_b32 s24, s2, 7
    s_lshl_b32 s24, s24, 3
    s_lshr_b64 s[16:17], s[16:17], s24
    s_add_u32 s24, s14, s16
    s_and_b32 s24, s24, 0xff
    s_cbranch_scc0 L_ld_loopa
    s_add_u32 s24, s24, 1
L_ld_loopx:
    s_sub_u32 s28, s25, 7
    s_waitcnt lgkmcnt(0)
    v_cmp_gt_i32 vcc, s28, v10
    s_cbranch_vccz L_ld_gox
L_ld_spinx:
    ds_read_b32 v10, v9 offset:256
    s_waitcnt lgkmcnt(0)
    v_cmp_gt_i32 vcc, s28, v10
    s_cbranch_vccnz L_ld_spinx
L_ld_gox:
    s_add_u32 s26, s26, 4096
    s_add_u32 m0, s27, 0
    s_and_b32 s26, s26, 0xfffff
    s_waitcnt vmcnt(21)
    buffer_load_dwordx4 v4, s[8:11], s26 offen offset:0 nt lds
    s_waitcnt vmcnt(21)
    buffer_load_dwordx4 v5, s[8:11], s26 offen offset:1024 nt lds
    s_waitcnt vmcnt(21)
    buffer_load_dwordx4 v6, s[8:11], s26 offen offset:2048 nt lds
    s_waitcnt vmcnt(21)
    buffer_load_dwordx4 v7, s[8:11], s26 offen offset:3072 nt lds
    s_add_u32 s26, s26, 4096
    s_add_u32 m0, s27, 4096
    s_and_b32 s26, s26, 0xfffff
    s_waitcnt vmcnt(21)
    buffer_load_dwordx4 v4, s[8:11], s26 offen offset:0 nt lds
    s_waitcnt vmcnt(21)
    buffer_load_dwordx4 v5, s[8:11], s26 offen offset:1024 nt lds
    s_sub_u32 s28, s25, 1
    s_max_i32 s29, s29, s28
    v_mov_b32 v2, s29
    ds_write_b32 v8, v2 offset:0
    s_waitcnt vmcnt(21)
    buffer_load_dwordx4 v6, s[8:11], s26 offen offset:2048 nt lds
    s_waitcnt vmcnt(21)
    buffer_load_dwordx4 v7, s[8:11], s26 offen offset:3072 nt lds
    s_add_u32 s26, s26, 4096
    s_add_u32 m0, s27, 8192
    s_and_b32 s26, s26, 0xfffff
    s_waitcnt vmcnt(21)
    buffer_load_dwordx4 v4, s[8:11], s26 offen offset:0 nt lds
    s_waitcnt vmcnt(21)
    buffer_load_dwordx4 v5, s[8:11], s26 offen offset:1024 nt lds
    s_waitcnt vmcnt(21)
    buffer_load_dwordx4 v6, s[8:11], s26 offen offset:2048 nt lds
    s_waitcnt vmcnt(21)
    buffer_load_dwordx4 v7, s[8:11], s26 offen offset:3072 nt lds
    s_add_u32 s26, s26, 4096
    s_add_u32 m0, s27, 12288
    s_and_b32 s26, s26, 0xfffff
    s_waitcnt vmcnt(21)
    buffer_load_dwordx4 v4, s[8:11], s26 offen offset:0 nt lds
    s_waitcnt vmcnt(21)
    buffer_load_dwordx4 v5, s[8:11], s26 offen offset:1024 nt lds
    s_waitcnt vmcnt(21)
    buffer_load_dwordx4 v6, s[8:11], s26 offen offset:2048 nt lds
    ds_read_b32 v10, v9 offset:256
    s_waitcnt vmcnt(21)
    buffer_load_dwordx4 v7, s[8:11], s26 offen offset:3072 nt lds
    s_add_u32 s25, s25, 1
    s_add_u32 s27, s27, 16384
    s_and_b32 s27, s27, 131071
    s_cmp_eq_u32 s25, 64
    s_cselect_b32 s8, s12, s8
    s_cselect_b32 s9, s13, s9
    s_cmp_lt_u32 s25, s24
    s_cbranch_scc1 L_ld_loopx
L_ld_loopa:
    s_sub_u32 s28, s25, 7
    s_waitcnt lgkmcnt(0)
    v_cmp_gt_i32 vcc, s28, v10
    s_cbranch_vccz L_ld_goa
L_ld_spina:
    ds_read_b32 v10, v9 offset:256
    s_waitcnt lgkmcnt(0)
    v_cmp_gt_i32 vcc, s28, v10
    s_cbranch_vccnz L_ld_spina
L_ld_goa:
    s_add_u32 s26, s26, 4096
    s_add_u32 m0, s27, 0
    s_and_b32 s26, s26, 0xfffff
    s_waitcnt vmcnt(19)
    buffer_load_dwordx4 v4, s[8:11], s26 offen offset:0 nt lds
    s_waitcnt vmcnt(19)
    buffer_load_dwordx4 v5, s[8:11], s26 offen offset:1024 nt lds
    s_waitcnt vmcnt(19)
    buffer_load_dwordx4 v6, s[8:11], s26 offen offset:2048 nt lds
    s_waitcnt vmcnt(19)
    buffer_load_dwordx4 v7, s[8:11], s26 offen offset:3072 nt lds
    s_sub_u32 s28, s25, 1
    s_max_i32 s29, s29, s28
    v_mov_b32 v2, s29
    ds_write_b32 v8, v2 offset:0
    s_add_u32 s26, s26, 4096
    s_add_u32 m0, s27, 4096
    s_and_b32 s26, s26, 0xfffff
    s_waitcnt vmcnt(19)
    buffer_load_dwordx4 v4, s[8:11], s26 offen offset:0 nt lds
    s_waitcnt vmcnt(19)
    buffer_load_dwordx4 v5, s[8:11], s26 offen offset:1024 nt lds
    s_waitcnt vmcnt(19)
    buffer_load_dwordx4 v6, s[8:11], s26 offen offset:2048 nt lds
    s_waitcnt vmcnt(19)
    buffer_load_dwordx4 v7, s[8:11], s26 offen offset:3072 nt lds
    s_add_u32 s26, s26, 4096
    s_add_u32 m0, s27, 8192
    s_and_b32 s26, s26, 0xfffff
    s_waitcnt vmcnt(19)
    buffer_load_dwordx4 v4, s[8:11], s26 offen offset:0 nt lds
    s_waitcnt vmcnt(19)
    buffer_load_dwordx4 v5, s[8:11], s26 offen offset:1024 nt lds
    s_waitcnt vmcnt(19)
    buffer_load_dwordx4 v6, s[8:11], s26 offen offset:2048 nt lds
    s_waitcnt vmcnt(19)
    buffer_load_dwordx4 v7, s[8:11], s26 offen offset:3072 nt lds
    s_add_u32 s26, s26, 4096
    s_add_u32 m0, s27, 12288
    s_and_b32 s26, s26, 0xfffff
    s_waitcnt vmcnt(19)
    buffer_load_dwordx4 v4, s[8:11], s26 offen offset:0 nt lds
    s_waitcnt vmcnt(19)
    buffer_load_dwordx4 v5, s[8:11], s26 offen offset:1024 nt lds
    s_waitcnt vmcnt(19)
    buffer_load_dwordx4 v6, s[8:11], s26 offen offset:2048 nt lds
    ds_read_b32 v10, v9 offset:256
    s_waitcnt vmcnt(19)
    buffer_load_dwordx4 v7, s[8:11], s26 offen offset:3072 nt lds
    s_add_u32 s25, s25, 1
    s_add_u32 s27, s27, 16384
    s_and_b32 s27, s27, 131071
    s_cmp_eq_u32 s25, 64
    s_cselect_b32 s8, s12, s8
    s_cselect_b32 s9, s13, s9
    s_cmp_lt_u32 s25, 112
    s_cbranch_scc1 L_ld_loopa
L_ld_loopb:
    s_sub_u32 s28, s25, 7
    s_waitcnt lgkmcnt(0)
    v_cmp_gt_i32 vcc, s28, v10
    s_cbranch_vccz L_ld_gob
L_ld_spinb:
    ds_read_b32 v10, v9 offset:256
    s_waitcnt lgkmcnt(0)
    v_cmp_gt_i32 vcc, s28, v10
    s_cbranch_vccnz L_ld_spinb
L_ld_gob:
    s_add_u32 s26, s26, 4096
    s_add_u32 m0, s27, 0
    s_and_b32 s26, s26, 0xfffff
    s_waitcnt vmcnt(47)
    buffer_load_dwordx4 v4, s[8:11], s26 offen offset:0 nt lds
    s_waitcnt vmcnt(47)
    buffer_load_dwordx4 v5, s[8:11], s26 offen offset:1024 nt lds
    s_waitcnt vmcnt(47)
    buffer_load_dwordx4 v6, s[8:11], s26 offen offset:2048 nt lds
    s_waitcnt vmcnt(47)
    buffer_load_dwordx4 v7, s[8:11], s26 offen offset:3072 nt lds
    s_add_u32 s26, s26, 4096
    s_add_u32 m0, s27, 4096
    s_and_b32 s26, s26, 0xfffff
    s_waitcnt vmcnt(47)
    buffer_load_dwordx4 v4, s[8:11], s26 offen offset:0 nt lds
    s_waitcnt vmcnt(47)
    buffer_load_dwordx4 v5, s[8:11], s26 offen offset:1024 nt lds
    s_waitcnt vmcnt(47)
    buffer_load_dwordx4 v6, s[8:11], s26 offen offset:2048 nt lds
    s_waitcnt vmcnt(47)
    buffer_load_dwordx4 v7, s[8:11], s26 offen offset:3072 nt lds
    s_add_u32 s26, s26, 4096
    s_add_u32 m0, s27, 8192
    s_and_b32 s26, s26, 0xfffff
    s_waitcnt vmcnt(47)
    buffer_load_dwordx4 v4, s[8:11], s26 offen offset:0 nt lds
    s_waitcnt vmcnt(47)
    buffer_load_dwordx4 v5, s[8:11], s26 offen offset:1024 nt lds
    s_waitcnt vmcnt(47)
    buffer_load_dwordx4 v6, s[8:11], s26 offen offset:2048 nt lds
    s_waitcnt vmcnt(47)
    buffer_load_dwordx4 v7, s[8:11], s26 offen offset:3072 nt lds
    s_add_u32 s26, s26, 4096
    s_add_u32 m0, s27, 12288
    s_and_b32 s26, s26, 0xfffff
    s_waitcnt vmcnt(47)
    buffer_load_dwordx4 v4, s[8:11], s26 offen offset:0 nt lds
    s_waitcnt vmcnt(47)
    buffer_load_dwordx4 v5, s[8:11], s26 offen offset:1024 nt lds
    s_waitcnt vmcnt(47)
    buffer_load_dwordx4 v6, s[8:11], s26 offen offset:2048 nt lds
    ds_read_b32 v10, v9 offset:256
    s_waitcnt vmcnt(47)
    buffer_load_dwordx4 v7, s[8:11], s26 offen offset:3072 nt lds
    s_sub_u32 s28, s25, 2
    s_max_i32 s29, s29, s28
    v_mov_b32 v2, s29
    ds_write_b32 v8, v2 offset:0
    s_add_u32 s25, s25, 1
    s_add_u32 s27, s27, 16384
    s_and_b32 s27, s27, 131071
    s_cmp_eq_u32 s25, 64
    s_cselect_b32 s8, s12, s8
    s_cselect_b32 s9, s13, s9
    s_cmp_lt_u32 s25, 126
    s_cbranch_scc1 L_ld_loopb
    v_and_b32 v1, 16, v0
    v_cmp_eq_u32 vcc, 0, v1
    s_add_u32 s26, s26, 4096
    s_and_b32 s26, s26, 0xfffff
    s_add_u32 s24, s26, 16384
    s_and_b32 s24, s24, 0xfffff
    s_sub_u32 s24, s24, 256
    v_mov_b32 v1, s24
    v_mov_b32 v3, s26
    s_add_u32 s26, s26, 32768
    v_cndmask_b32 v1, v1, v3, vcc
    v_add_u32 v24, v1, v4
    v_add_u32 v25, v1, v5
    v_add_u32 v26, v1, v6
    v_add_u32 v27, v1, v7
    s_mov_b32 s26, 1044480
L_ld_loopz0:
    s_sub_u32 s28, s25, 7
    s_waitcnt lgkmcnt(0)
    v_cmp_gt_i32 vcc, s28, v10
    s_cbranch_vccz L_ld_goz0
L_ld_spinz0:
    ds_read_b32 v10, v9 offset:256
    s_waitcnt lgkmcnt(0)
    v_cmp_gt_i32 vcc, s28, v10
    s_cbranch_vccnz L_ld_spinz0
L_ld_goz0:
    s_add_u32 s26, s26, 4096
    s_add_u32 m0, s27, 0
    s_and_b32 s26, s26, 0xfffff
    s_waitcnt vmcnt(47)
    buffer_load_dwordx4 v24, s[8:11], s26 offen offset:0 nt lds
    s_waitcnt vmcnt(47)
    buffer_load_dwordx4 v25, s[8:11], s26 offen offset:1024 nt lds
    s_waitcnt vmcnt(47)
    buffer_load_dwordx4 v26, s[8:11], s26 offen offset:2048 nt lds
    s_waitcnt vmcnt(47)
    buffer_load_dwordx4 v27, s[8:11], s26 offen offset:3072 nt lds
    s_add_u32 s26, s26, 4096
    s_add_u32 m0, s27, 4096
    s_and_b32 s26, s26, 0xfffff
    s_waitcnt vmcnt(47)
    buffer_load_dwordx4 v24, s[8:11], s26 offen offset:0 nt lds
    s_waitcnt vmcnt(47)
    buffer_load_dwordx4 v25, s[8:11], s26 offen offset:1024 nt lds
    s_waitcnt vmcnt(47)
    buffer_load_dwordx4 v26, s[8:11], s26 offen offset:2048 nt lds
    s_waitcnt vmcnt(47)
    buffer_load_dwordx4 v27, s[8:11], s26 offen offset:3072 nt lds
    s_add_u32 s26, s26, 4096
    s_add_u32 m0, s27, 8192
    s_and_b32 s26, s26, 0xfffff
    s_waitcnt vmcnt(47)
    buffer_load_dwordx4 v24, s[8:11], s26 offen offset:0 nt lds
    s_waitcnt vmcnt(47)
    buffer_load_dwordx4 v25, s[8:11], s26 offen offset:1024 nt lds
    s_waitcnt vmcnt(47)
    buffer_load_dwordx4 v26, s[8:11], s26 offen offset:2048 nt lds
    s_waitcnt vmcnt(47)
    buffer_load_dwordx4 v27, s[8:11], s26 offen offset:3072 nt lds
    s_add_u32 s26, s26, 4096
    s_add_u32 m0, s27, 12288
    s_and_b32 s26, s26, 0xfffff
    s_waitcnt vmcnt(47)
    buffer_load_dwordx4 v24, s[8:11], s26 offen offset:0 nt lds
    s_waitcnt vmcnt(47)
    buffer_load_dwordx4 v25, s[8:11], s26 offen offset:1024 nt lds
    s_waitcnt vmcnt(47)
    buffer_load_dwordx4 v26, s[8:11], s26 offen offset:2048 nt lds
    ds_read_b32 v10, v9 offset:256
    s_waitcnt vmcnt(47)
    buffer_load_dwordx4 v27, s[8:11], s26 offen offset:3072 nt lds
    s_sub_u32 s28, s25, 2
    s_max_i32 s29, s29, s28
    v_mov_b32 v2, s29
    ds_write_b32 v8, v2 offset:0
    s_add_u32 s25, s25, 1
    s_add_u32 s27, s27, 16384
    s_and_b32 s27, s27, 131071
    s_cmp_eq_u32 s25, 64
    s_cselect_b32 s8, s12, s8
    s_cselect_b32 s9, s13, s9
    s_cmp_lt_u32 s25, 0
    s_cbranch_scc1 L_ld_loopz0
    s_mov_b32 s26, 1044736
L_ld_loopz1:
    s_sub_u32 s28, s25, 7
    s_waitcnt lgkmcnt(0)
    v_cmp_gt_i32 vcc, s28, v10
    s_cbranch_vccz L_ld_goz1
L_ld_spinz1:
    ds_read_b32 v10, v9 offset:256
    s_waitcnt lgkmcnt(0)
    v_cmp_gt_i32 vcc, s28, v10
    s_cbranch_vccnz L_ld_spinz1
L_ld_goz1:
    s_add_u32 s26, s26, 4096
    s_add_u32 m0, s27, 0
    s_and_b32 s26, s26, 0xfffff
    s_waitcnt vmcnt(47)
    buffer_load_dwordx4 v24, s[8:11], s26 offen offset:0 nt lds
    s_waitcnt vmcnt(47)
    buffer_load_dwordx4 v25, s[8:11], s26 offen offset:1024 nt lds
    s_waitcnt vmcnt(47)
    buffer_load_dwordx4 v26, s[8:11], s26 offen offset:2048 nt lds
    s_waitcnt vmcnt(47)
    buffer_load_dwordx4 v27, s[8:11], s26 offen offset:3072 nt lds
    s_add_u32 s26, s26, 4096
    s_add_u32 m0, s27, 4096
    s_and_b32 s26, s26, 0xfffff
    s_waitcnt vmcnt(47)
    buffer_load_dwordx4 v24, s[8:11], s26 offen offset:0 nt lds
    s_waitcnt vmcnt(47)
    buffer_load_dwordx4 v25, s[8:11], s26 offen offset:1024 nt lds
    s_waitcnt vmcnt(47)
    buffer_load_dwordx4 v26, s[8:11], s26 offen offset:2048 nt lds
    s_waitcnt vmcnt(47)
    buffer_load_dwordx4 v27, s[8:11], s26 offen offset:3072 nt lds
    s_add_u32 s26, s26, 4096
    s_add_u32 m0, s27, 8192
    s_and_b32 s26, s26, 0xfffff
    s_waitcnt vmcnt(47)
    buffer_load_dwordx4 v24, s[8:11], s26 offen offset:0 nt lds
    s_waitcnt vmcnt(47)
    buffer_load_dwordx4 v25, s[8:11], s26 offen offset:1024 nt lds
    s_waitcnt vmcnt(47)
    buffer_load_dwordx4 v26, s[8:11], s26 offen offset:2048 nt lds
    s_waitcnt vmcnt(47)
    buffer_load_dwordx4 v27, s[8:11], s26 offen offset:3072 nt lds
    s_add_u32 s26, s26, 4096
    s_add_u32 m0, s27, 12288
    s_and_b32 s26, s26, 0xfffff
    s_waitcnt vmcnt(47)
    buffer_load_dwordx4 v24, s[8:11], s26 offen offset:0 nt lds
    s_waitcnt vmcnt(47)
    buffer_load_dwordx4 v25, s[8:11], s26 offen offset:1024 nt lds
    s_waitcnt vmcnt(47)
    buffer_load_dwordx4 v26, s[8:11], s26 offen offset:2048 nt lds
    ds_read_b32 v10, v9 offset:256
    s_waitcnt vmcnt(47)
    buffer_load_dwordx4 v27, s[8:11], s26 offen offset:3072 nt lds
    s_sub_u32 s28, s25, 2
    s_max_i32 s29, s29, s28
    v_mov_b32 v2, s29
    ds_write_b32 v8, v2 offset:0
    s_add_u32 s25, s25, 1
    s_add_u32 s27, s27, 16384
    s_and_b32 s27, s27, 131071
    s_cmp_eq_u32 s25, 64
    s_cselect_b32 s8, s12, s8
    s_cselect_b32 s9, s13, s9
    s_cmp_lt_u32 s25, 0
    s_cbranch_scc1 L_ld_loopz1
    v_mov_b32 v2, 126
    s_waitcnt vmcnt(32)
    ds_write_b32 v8, v2 offset:0
    v_mov_b32 v2, 127
    s_waitcnt vmcnt(16)
    ds_write_b32 v8, v2 offset:0
    s_waitcnt vmcnt(0)
    s_barrier
    s_waitcnt lgkmcnt(0)
    s_endpgm
L_worker:
    s_sub_u32 s4, s3, 1
    v_lshlrev_b32 v12, 4, v0
    s_mul_i32 s24, s4, 896
    s_mov_b32 s10, 896
    s_mov_b32 s11, 0x20000
    s_waitcnt lgkmcnt(0)
    s_add_u32 s8, s32, s24
    s_addc_u32 s9, s33, 0
    s_load_dword s84, s[54:55], 0
    buffer_load_dwordx4 v[16:19], v12, s[8:11], 0 offen
    s_barrier
    s_mov_b32 s12, s40
    s_mov_b32 s13, s41
    s_mov_b32 s14, 3670016
    s_mov_b32 s15, 0x20000
    s_mov_b32 s27, 0
    s_mov_b32 s26, 0
    v_mov_b32 v21, 0
    s_cmp_lg_u32 s4, 7
    s_cbranch_scc1 L_nowq
    v_lshrrev_b32 v2, 1, v0
    v_and_b32 v3, 1, v0
    v_lshlrev_b32 v2, 13, v2
    v_lshl_add_u32 v21, v3, 4, v2
    s_and_b32 s26, s2, 7
    s_lshl_b32 s26, s26, 10
    s_lshr_b32 s27, s2, 3
    s_xor_b32 s27, s27, 0
    s_lshl_b32 s27, s27, 5
    s_mov_b32 m0, 135168
    s_add_u32 s26, s26, s27
    buffer_load_dwordx4 v21, s[12:15], s26 offen  lds
    s_mov_b32 m0, 136192
    s_add_u32 s26, s26, 262144
    buffer_load_dwordx4 v21, s[12:15], s26 offen  lds
    s_mov_b32 m0, 137216
    s_add_u32 s26, s26, 262144
    buffer_load_dwordx4 v21, s[12:15], s26 offen  lds
    s_mov_b32 m0, 138240
    s_add_u32 s26, s26, 262144
    buffer_load_dwordx4 v21, s[12:15], s26 offen  lds
    s_mov_b32 m0, 139264
    s_add_u32 s26, s26, 262144
    buffer_load_dwordx4 v21, s[12:15], s26 offen  lds
    s_mov_b32 m0, 140288
    s_add_u32 s26, s26, 262144
    buffer_load_dwordx4 v21, s[12:15], s26 offen  lds
    s_mov_b32 m0, 141312
    s_add_u32 s26, s26, 262144
    buffer_load_dwordx4 v21, s[12:15], s26 offen  lds
    s_mov_b32 m0, 142336
    s_add_u32 s26, s26, 262144
    buffer_load_dwordx4 v21, s[12:15], s26 offen  lds
    s_mov_b32 m0, 143360
    s_add_u32 s26, s26, 262144
    buffer_load_dwordx4 v21, s[12:15], s26 offen  lds
    s_mov_b32 m0, 144384
    s_add_u32 s26, s26, 262144
    buffer_load_dwordx4 v21, s[12:15], s26 offen  lds
    s_mov_b32 m0, 145408
    s_add_u32 s26, s26, 262144
    buffer_load_dwordx4 v21, s[12:15], s26 offen  lds
    s_mov_b32 m0, 146432
    s_add_u32 s26, s26, 262144
    buffer_load_dwordx4 v21, s[12:15], s26 offen  lds
    s_mov_b32 m0, 147456
    s_add_u32 s26, s26, 262144
    buffer_load_dwordx4 v21, s[12:15], s26 offen  lds
    s_mov_b32 m0, 148480
    s_add_u32 s26, s26, 262144
    buffer_load_dwordx4 v21, s[12:15], s26 offen  lds
    s_branch L_nosw
L_nowq:
    s_and_b32 s24, s2, 7
    s_mul_i32 s24, s24, 28
    s_lshr_b32 s25, s2, 3
    s_add_u32 s24, s24, s25
    s_lshr_b32 s25, s2, 7
    s_lshl_b32 s25, s25, 2
    s_sub_u32 s24, s24, s25
    s_mul_i32 s25, s24, 7168
    s_mul_i32 s24, s24, 16384
    s_cmp_ge_u32 s4, 5
    s_cselect_b32 s88, s40, s42
    s_cselect_b32 s89, s41, s43
    s_mov_b32 s90, 8192
    s_mov_b32 s91, 0x20000
    s_bitcmp1_b32 s4, 0
    s_cselect_b32 s85, 8192, 0
    s_add_u32 s24, s24, s85
    s_cmp_eq_u32 s4, 0
    s_cselect_b32 s88, s44, s88
    s_cselect_b32 s89, s45, s89
    s_cselect_b32 s90, 7168, s90
    s_cselect_b32 s24, s25, s24
    s_cmp_eq_u32 s4, 1
    s_cselect_b32 s88, s46, s88
    s_cselect_b32 s89, s47, s89
    s_cselect_b32 s90, 7168, s90
    s_cselect_b32 s24, s25, s24
    s_cmp_eq_u32 s4, 2
    s_cselect_b32 s88, s48, s88
    s_cselect_b32 s89, s49, s89
    s_cselect_b32 s90, 7168, s90
    s_cselect_b32 s24, s25, s24
    s_add_u32 s88, s88, s24
    s_addc_u32 s89, s89, 0
    v_lshlrev_b32 v2, 4, v0
    v_add_u32 v38, 4096, v2
    s_lshr_b32 s24, 24, s4
    s_lshr_b32 s25, s2, 5
    s_cmp_eq_u32 s25, 3
    s_cselect_b32 s24, 0, s24
    s_bitcmp1_b32 s24, 0
    s_cselect_b32 s90, s90, 0
    buffer_load_dwordx4 v[136:139], v2, s[88:91], 0 offen offset:0
    buffer_load_dwordx4 v[136:139], v2, s[88:91], 0 offen offset:1024
    buffer_load_dwordx4 v[136:139], v2, s[88:91], 0 offen offset:2048
    buffer_load_dwordx4 v[136:139], v2, s[88:91], 0 offen offset:3072
    buffer_load_dwordx4 v[136:139], v38, s[88:91], 0 offen offset:0
    buffer_load_dwordx4 v[136:139], v38, s[88:91], 0 offen offset:1024
    buffer_load_dwordx4 v[136:139], v38, s[88:91], 0 offen offset:2048
    buffer_load_dwordx4 v[136:139], v38, s[88:91], 0 offen offset:3072
L_nosw:
    s_mul_i32 s24, s7, 2304
    s_add_u32 s24, s24, 262144
    s_add_u32 s16, s54, s24
    s_addc_u32 s17, s55, 0
    s_mov_b32 s18, 2304
    s_mov_b32 s19, 0x20000
    s_mov_b32 s20, s54
    s_mov_b32 s21, s55
    s_mov_b32 s22, 1073741824
    s_mov_b32 s23, 0x20000
    v_and_b32 v3, 15, v0
    v_and_b32 v1, 1, v3
    v_cmp_eq_u32 vcc, 1, v1
    v_mov_b32 v14, 0xffff
    v_mov_b32 v15, 0xffff0000
    v_cndmask_b32 v14, v14, v15, vcc
    v_lshrrev_b32 v1, 1, v3
    v_cmp_eq_u32 vcc, 0, v1
    s_nop 1
    v_cndmask_b32 v4, 0, v14, vcc
    v_cmp_eq_u32 vcc, 1, v1
    s_nop 1
    v_cndmask_b32 v5, 0, v14, vcc
    v_cmp_eq_u32 vcc, 2, v1
    s_nop 1
    v_cndmask_b32 v6, 0, v14, vcc
    v_cmp_eq_u32 vcc, 3, v1
    s_nop 1
    v_cndmask_b32 v7, 0, v14, vcc
    v_and_b32 v8, 7, v0
    v_lshlrev_b32 v8, 2, v8
    v_add_u32 v8, 151552, v8
    s_lshl_b32 s25, s4, 2
    s_add_u32 s25, s25, 151552
    v_mov_b32 v9, s25
    v_add_u32 v10, 135168, v12
    s_lshl_b32 s25, s4, 10
    v_add_u32 v11, s25, v10
    s_mul_i32 s25, s4, 960
    s_add_u32 s25, s25, 152576
    v_add_u32 v12, s25, v12
    v_mov_b32 v1, s4
    s_mov_b64 exec, 1
    ds_write_b32 v9, v1 offset:256
    s_mov_b64 exec, -1
    v_lshrrev_b32 v2, 4, v0
    v_and_b32 v3, 7, v0
    v_lshlrev_b32 v13, 4, v2
    v_add_u32 v13, 131072, v13
    v_lshlrev_b32 v3, 1, v3
    v_xor_b32 v3, v3, v2
    v_lshlrev_b32 v3, 4, v3
    v_and_b32 v2, 15, v0
    v_lshl_add_u32 v3, v2, 9, v3
    s_lshl_b32 s25, s4, 14
    v_add_u32 v164, s25, v3
    v_xor_b32 v165, 64, v164
    v_xor_b32 v166, 0x80, v164
    v_xor_b32 v167, 0xc0, v164
    s_cmp_lg_u32 s4, 7
    s_cbranch_scc1 L_xw0
    s_waitcnt vmcnt(14)
    s_branch L_xw1
L_xw0:
    s_waitcnt vmcnt(8)
L_xw1:
    v_lshlrev_b32 v32, 16, v16
    v_and_b32 v33, 0xffff0000, v16
    v_lshlrev_b32 v34, 16, v17
    v_and_b32 v35, 0xffff0000, v17
    v_lshlrev_b32 v36, 16, v18
    v_and_b32 v37, 0xffff0000, v18
    v_lshlrev_b32 v38, 16, v19
    v_and_b32 v39, 0xffff0000, v19
    v_add_f32 v1, v32, v33
    v_add_f32 v1, v1, v34
    v_add_f32 v1, v1, v35
    v_add_f32 v1, v1, v36
    v_add_f32 v1, v1, v37
    v_add_f32 v1, v1, v38
    v_add_f32 v1, v1, v39
    s_nop 1
    v_add_f32_dpp v1, v1, v1 quad_perm:[1,0,3,2] row_mask:0xf bank_mask:0xf
    s_nop 1
    v_add_f32_dpp v1, v1, v1 quad_perm:[2,3,0,1] row_mask:0xf bank_mask:0xf
    s_nop 1
    v_add_f32_dpp v1, v1, v1 row_half_mirror row_mask:0xf bank_mask:0xf
    s_nop 1
    v_add_f32_dpp v1, v1, v1 row_mirror row_mask:0xf bank_mask:0xf
    v_mov_b32 v2, v1
    s_nop 1
    v_permlane16_swap_b32 v1, v2
    s_nop 1
    v_add_f32 v1, v1, v2
    v_mov_b32 v2, v1
    s_nop 1
    v_permlane32_swap_b32 v1, v2
    s_nop 1
    v_add_f32 v1, v1, v2
    v_mul_f32 v1, 991054117, v1
    v_mov_b32 v3, 0
    v_sub_f32 v2, v32, v1
    v_fmac_f32 v3, v2, v2
    v_sub_f32 v2, v33, v1
    v_fmac_f32 v3, v2, v2
    v_sub_f32 v2, v34, v1
    v_fmac_f32 v3, v2, v2
    v_sub_f32 v2, v35, v1
    v_fmac_f32 v3, v2, v2
    v_sub_f32 v2, v36, v1
    v_fmac_f32 v3, v2, v2
    v_sub_f32 v2, v37, v1
    v_fmac_f32 v3, v2, v2
    v_sub_f32 v2, v38, v1
    v_fmac_f32 v3, v2, v2
    v_sub_f32 v2, v39, v1
    v_fmac_f32 v3, v2, v2
    v_cmp_gt_u32 vcc, 56, v0
    s_nop 1
    v_cndmask_b32 v3, 0, v3, vcc
    s_nop 1
    v_add_f32_dpp v3, v3, v3 quad_perm:[1,0,3,2] row_mask:0xf bank_mask:0xf
    s_nop 1
    v_add_f32_dpp v3, v3, v3 quad_perm:[2,3,0,1] row_mask:0xf bank_mask:0xf
    s_nop 1
    v_add_f32_dpp v3, v3, v3 row_half_mirror row_mask:0xf bank_mask:0xf
    s_nop 1
    v_add_f32_dpp v3, v3, v3 row_mirror row_mask:0xf bank_mask:0xf
    v_mov_b32 v2, v3
    s_nop 1
    v_permlane16_swap_b32 v3, v2
    s_nop 1
    v_add_f32 v3, v3, v2
    v_mov_b32 v2, v3
    s_nop 1
    v_permlane32_swap_b32 v3, v2
    s_nop 1
    v_add_f32 v3, v3, v2
    v_mul_f32 v3, 991054117, v3
    v_cvt_pk_bf16_f32 v1, v1, v1
    v_and_b32 v1, 0xffff0000, v1
    v_cvt_pk_bf16_f32 v3, v3, v3
    v_and_b32 v3, 0xffff0000, v3
    v_add_f32 v3, 925353388, v3
    v_cvt_pk_bf16_f32 v3, v3, v3
    v_and_b32 v3, 0xffff0000, v3
    v_sqrt_f32 v3, v3
    s_nop 0
    v_cvt_pk_bf16_f32 v3, v3, v3
    v_and_b32 v3, 0xffff0000, v3
    v_rcp_f32 v2, v3
    s_nop 0
    v_fma_f32 v14, -v3, v2, 1.0
    v_fmac_f32 v2, v14, v2
    v_sub_f32 v32, v32, v1
    v_sub_f32 v33, v33, v1
    v_sub_f32 v34, v34, v1
    v_sub_f32 v35, v35, v1
    v_sub_f32 v36, v36, v1
    v_sub_f32 v37, v37, v1
    v_sub_f32 v38, v38, v1
    v_sub_f32 v39, v39, v1
    v_cvt_pk_bf16_f32 v32, v32, v32
    v_and_b32 v32, 0xffff0000, v32
    v_cvt_pk_bf16_f32 v33, v33, v33
    v_and_b32 v33, 0xffff0000, v33
    v_cvt_pk_bf16_f32 v34, v34, v34
    v_and_b32 v34, 0xffff0000, v34
    v_cvt_pk_bf16_f32 v35, v35, v35
    v_and_b32 v35, 0xffff0000, v35
    v_cvt_pk_bf16_f32 v36, v36, v36
    v_and_b32 v36, 0xffff0000, v36
    v_cvt_pk_bf16_f32 v37, v37, v37
    v_and_b32 v37, 0xffff0000, v37
    v_cvt_pk_bf16_f32 v38, v38, v38
    v_and_b32 v38, 0xffff0000, v38
    v_cvt_pk_bf16_f32 v39, v39, v39
    v_and_b32 v39, 0xffff0000, v39
    v_mul_f32 v24, v32, v2
    v_mul_f32 v25, v33, v2
    v_mul_f32 v26, v34, v2
    v_mul_f32 v27, v35, v2
    v_mul_f32 v28, v36, v2
    v_mul_f32 v29, v37, v2
    v_mul_f32 v30, v38, v2
    v_mul_f32 v31, v39, v2
    v_fma_f32 v32, -v24, v3, v32
    v_fma_f32 v33, -v25, v3, v33
    v_fma_f32 v34, -v26, v3, v34
    v_fma_f32 v35, -v27, v3, v35
    v_fma_f32 v36, -v28, v3, v36
    v_fma_f32 v37, -v29, v3, v37
    v_fma_f32 v38, -v30, v3, v38
    v_fma_f32 v39, -v31, v3, v39
    v_fmac_f32 v24, v32, v2
    v_fmac_f32 v25, v33, v2
    v_fmac_f32 v26, v34, v2
    v_fmac_f32 v27, v35, v2
    v_fmac_f32 v28, v36, v2
    v_fmac_f32 v29, v37, v2
    v_fmac_f32 v30, v38, v2
    v_fmac_f32 v31, v39, v2
    v_cvt_pk_bf16_f32 v16, v24, v25
    v_cvt_pk_bf16_f32 v17, v26, v27
    v_cvt_pk_bf16_f32 v18, v28, v29
    v_cvt_pk_bf16_f32 v19, v30, v31
    s_mov_b32 exec_hi, 0x00ffffff
    ds_write_b128 v12, v[16:19]
    s_mov_b32 exec_hi, -1
    s_waitcnt lgkmcnt(0)
    s_add_u32 s84, s84, 0x01010101
    s_and_b32 s80, s84, 0xff
    s_bfe_u32 s81, s84, 0x80008
    s_bfe_u32 s82, s84, 0x80010
    s_lshr_b32 s83, s84, 24
    v_mov_b32 v1, 1
    s_mov_b64 exec, 1
    ds_write_b32 v9, v1 offset:320
    s_mov_b64 exec, -1
    s_cmp_lg_u32 s4, 7
    s_cbranch_scc1 L_noq
    v_lshrrev_b32 v2, 4, v0
    v_and_b32 v3, 15, v0
    v_lshlrev_b32 v14, 8, v2
    v_lshl_add_u32 v14, v3, 3, v14
    v_add_u32 v14, 135168, v14
    v_and_b32 v1, 7, v0
    v_mul_u32_u24 v15, 960, v1
    v_lshl_add_u32 v15, v2, 4, v15
    v_add_u32 v15, 152576, v15
    v_lshlrev_b32 v3, 6, v3
    v_lshl_add_u32 v2, v2, 4, v3
    s_and_b32 s24, s2, 7
    s_lshl_b32 s24, s24, 14
    s_lshr_b32 s25, s2, 3
    s_xor_b32 s25, s25, 0
    s_lshl_b32 s25, s25, 9
    s_add_u32 s24, s24, s25
    s_add_u32 s24, s24, 4096
    s_lshr_b32 s25, s6, 1
    s_lshl_b32 s25, s25, 13
    s_lshl_b32 s26, s5, 6
    s_add_u32 s25, s25, s26
    s_add_u32 s25, s25, 4096
    v_lshrrev_b32 v1, 2, v0
    v_and_b32 v3, 3, v0
    v_lshlrev_b32 v3, 4, v3
    v_lshl_add_u32 v3, v1, 9, v3
L_w1:
    ds_read_b32 v1, v8 offset:320
    s_waitcnt lgkmcnt(0)
    v_cmp_gt_i32 vcc, 1, v1
    s_cbranch_vccz L_wd2
    s_branch L_w1
L_wd2:
    ds_read_b128 v[40:43], v15 offset:0
    ds_read_b128 v[44:47], v15 offset:64
    ds_read_b128 v[48:51], v15 offset:128
    ds_read_b128 v[52:55], v15 offset:192
    ds_read_b128 v[56:59], v15 offset:256
    ds_read_b128 v[60:63], v15 offset:320
    ds_read_b128 v[64:67], v15 offset:384
    ds_read_b128 v[68:71], v15 offset:448
    ds_read_b128 v[72:75], v15 offset:512
    ds_read_b128 v[76:79], v15 offset:576
    ds_read_b128 v[80:83], v15 offset:640
    ds_read_b128 v[84:87], v15 offset:704
    ds_read_b128 v[88:91], v15 offset:768
    ds_read_b128 v[92:95], v15 offset:832
    s_waitcnt vmcnt(0) lgkmcnt(0)
    ds_read_b64_tr_b16 v[96:97], v14 offset:0
    ds_read_b64_tr_b16 v[98:99], v14 offset:128
    ds_read_b64_tr_b16 v[100:101], v14 offset:1024
    ds_read_b64_tr_b16 v[102:103], v14 offset:1152
    ds_read_b64_tr_b16 v[104:105], v14 offset:2048
    ds_read_b64_tr_b16 v[106:107], v14 offset:2176
    ds_read_b64_tr_b16 v[108:109], v14 offset:3072
    ds_read_b64_tr_b16 v[110:111], v14 offset:3200
    ds_read_b64_tr_b16 v[112:113], v14 offset:4096
    ds_read_b64_tr_b16 v[114:115], v14 offset:4224
    ds_read_b64_tr_b16 v[116:117], v14 offset:5120
    ds_read_b64_tr_b16 v[118:119], v14 offset:5248
    ds_read_b64_tr_b16 v[120:121], v14 offset:6144
    ds_read_b64_tr_b16 v[122:123], v14 offset:6272
    s_waitcnt lgkmcnt(12)
    v_mfma_f32_16x16x32_bf16 v[16:19], v[96:99], v[40:43], 0
    ds_read_b64_tr_b16 v[124:125], v14 offset:7168
    ds_read_b64_tr_b16 v[126:127], v14 offset:7296
    s_waitcnt lgkmcnt(12)
    v_mfma_f32_16x16x32_bf16 v[20:23], v[100:103], v[44:47], 0
    ds_read_b64_tr_b16 v[128:129], v14 offset:8192
    ds_read_b64_tr_b16 v[130:131], v14 offset:8320
    s_waitcnt lgkmcnt(12)
    v_mfma_f32_16x16x32_bf16 v[16:19], v[104:107], v[48:51], v[16:19]
    ds_read_b64_tr_b16 v[132:133], v14 offset:9216
    ds_read_b64_tr_b16 v[134:135], v14 offset:9344
    s_waitcnt lgkmcnt(12)
    v_mfma_f32_16x16x32_bf16 v[20:23], v[108:111], v[52:55], v[20:23]
    ds_read_b64_tr_b16 v[136:137], v14 offset:10240
    ds_read_b64_tr_b16 v[138:139], v14 offset:10368
    s_waitcnt lgkmcnt(12)
    v_mfma_f32_16x16x32_bf16 v[16:19], v[112:115], v[56:59], v[16:19]
    ds_read_b64_tr_b16 v[140:141], v14 offset:11264
    ds_read_b64_tr_b16 v[142:143], v14 offset:11392
    s_waitcnt lgkmcnt(12)
    v_mfma_f32_16x16x32_bf16 v[20:23], v[116:119], v[60:63], v[20:23]
    ds_read_b64_tr_b16 v[144:145], v14 offset:12288
    ds_read_b64_tr_b16 v[146:147], v14 offset:12416
    s_waitcnt lgkmcnt(12)
    v_mfma_f32_16x16x32_bf16 v[16:19], v[120:123], v[64:67], v[16:19]
    ds_read_b64_tr_b16 v[148:149], v14 offset:13312
    ds_read_b64_tr_b16 v[150:151], v14 offset:13440
    s_waitcnt lgkmcnt(12)
    v_mfma_f32_16x16x32_bf16 v[20:23], v[124:127], v[68:71], v[20:23]
    s_waitcnt lgkmcnt(10)
    v_mfma_f32_16x16x32_bf16 v[16:19], v[128:131], v[72:75], v[16:19]
    s_waitcnt lgkmcnt(8)
    v_mfma_f32_16x16x32_bf16 v[20:23], v[132:135], v[76:79], v[20:23]
    s_waitcnt lgkmcnt(6)
    v_mfma_f32_16x16x32_bf16 v[16:19], v[136:139], v[80:83], v[16:19]
    s_waitcnt lgkmcnt(4)
    v_mfma_f32_16x16x32_bf16 v[20:23], v[140:143], v[84:87], v[20:23]
    s_waitcnt lgkmcnt(2)
    v_mfma_f32_16x16x32_bf16 v[16:19], v[144:147], v[88:91], v[16:19]
    s_waitcnt lgkmcnt(0)
    v_mfma_f32_16x16x32_bf16 v[20:23], v[148:151], v[92:95], v[20:23]
    s_nop 7
    v_add_f32 v16, v16, v20
    v_add_f32 v17, v17, v21
    v_add_f32 v18, v18, v22
    v_add_f32 v19, v19, v23
    v_cvt_pk_bf16_f32 v16, v16, v16
    v_and_b32 v16, 0xffff0000, v16
    v_cvt_pk_bf16_f32 v17, v17, v17
    v_and_b32 v17, 0xffff0000, v17
    v_cvt_pk_bf16_f32 v18, v18, v18
    v_and_b32 v18, 0xffff0000, v18
    v_cvt_pk_bf16_f32 v19, v19, v19
    v_and_b32 v19, 0xffff0000, v19
    v_or_b32 v16, s80, v16
    v_or_b32 v17, s81, v17
    v_or_b32 v18, s82, v18
    v_or_b32 v19, s83, v19
    s_mov_b32 exec_lo, 0x00ff00ff
    s_mov_b32 exec_hi, 0x00ff00ff
    buffer_store_dwordx4 v[16:19], v2, s[20:23], s24 offen sc1
    s_mov_b64 exec, -1
    v_lshlrev_b32 v14, 3, v0
    v_add_u32 v14, 131072, v14
    s_mov_b32 s26, 0x07060302
    s_mov_b32 s27, s25
L_noq:
    s_mov_b32 s28, 0
    s_add_u32 s29, s4, 1
    s_mov_b32 s30, 0x01010101
    s_mov_b32 s31, 0x01010101
L_w3:
    ds_read_b32 v1, v8 offset:0
    s_waitcnt lgkmcnt(0)
    v_cmp_gt_i32 vcc, s29, v1
    s_cbranch_vccz L_wd4
    s_branch L_w3
L_wd4:
    ds_read_b128 v[72:75], v164 offset:0
    ds_read_b128 v[76:79], v164 offset:8192
    ds_read_b128 v[80:83], v165 offset:0
    ds_read_b128 v[84:87], v165 offset:8192
    ds_read_b128 v[88:91], v166 offset:0
    ds_read_b128 v[92:95], v166 offset:8192
    ds_read_b128 v[96:99], v167 offset:0
    ds_read_b128 v[100:103], v167 offset:8192
    s_waitcnt lgkmcnt(4)
    ds_read_b128 v[104:107], v164 offset:256
    ds_read_b128 v[108:111], v164 offset:8448
    ds_read_b128 v[112:115], v165 offset:256
    ds_read_b128 v[116:119], v165 offset:8448
    ds_read_b128 v[120:123], v166 offset:256
    ds_read_b128 v[124:127], v166 offset:8448
    ds_read_b128 v[128:131], v167 offset:256
    ds_read_b128 v[132:135], v167 offset:8448
    s_add_u32 s25, s4, 8
    v_mov_b32 v1, s25
    s_mov_b64 exec, 1
    ds_write_b32 v9, v1 offset:256
    s_mov_b64 exec, -1
    s_and_b32 s24, s2, 7
    s_mul_i32 s24, s24, 28
    s_lshr_b32 s25, s2, 3
    s_add_u32 s24, s24, s25
    s_lshr_b32 s25, s2, 7
    s_lshl_b32 s25, s25, 2
    s_sub_u32 s24, s24, s25
    s_mul_i32 s25, s24, 7168
    s_mul_i32 s24, s24, 16384
    s_cmp_ge_u32 s4, 5
    s_cselect_b32 s88, s40, s42
    s_cselect_b32 s89, s41, s43
    s_mov_b32 s90, 8192
    s_mov_b32 s91, 0x20000
    s_bitcmp1_b32 s4, 0
    s_cselect_b32 s85, 8192, 0
    s_add_u32 s24, s24, s85
    s_cmp_eq_u32 s4, 0
    s_cselect_b32 s88, s44, s88
    s_cselect_b32 s89, s45, s89
    s_cselect_b32 s90, 7168, s90
    s_cselect_b32 s24, s25, s24
    s_cmp_eq_u32 s4, 1
    s_cselect_b32 s88, s46, s88
    s_cselect_b32 s89, s47, s89
    s_cselect_b32 s90, 7168, s90
    s_cselect_b32 s24, s25, s24
    s_cmp_eq_u32 s4, 2
    s_cselect_b32 s88, s48, s88
    s_cselect_b32 s89, s49, s89
    s_cselect_b32 s90, 7168, s90
    s_cselect_b32 s24, s25, s24
    s_add_u32 s88, s88, s24
    s_addc_u32 s89, s89, 0
    v_lshlrev_b32 v2, 4, v0
    v_add_u32 v38, 4096, v2
    s_lshr_b32 s24, 7, s4
    s_lshr_b32 s25, s2, 5
    s_cmp_eq_u32 s25, 3
    s_cselect_b32 s24, 0, s24
    s_bitcmp1_b32 s24, 0
    s_cbranch_scc0 L_nopf
    buffer_load_dwordx4 v[136:139], v2, s[88:91], 0 offen offset:0
    buffer_load_dwordx4 v[136:139], v2, s[88:91], 0 offen offset:1024
    buffer_load_dwordx4 v[136:139], v2, s[88:91], 0 offen offset:2048
    buffer_load_dwordx4 v[136:139], v2, s[88:91], 0 offen offset:3072
    buffer_load_dwordx4 v[136:139], v38, s[88:91], 0 offen offset:0
    buffer_load_dwordx4 v[136:139], v38, s[88:91], 0 offen offset:1024
    buffer_load_dwordx4 v[136:139], v38, s[88:91], 0 offen offset:2048
    buffer_load_dwordx4 v[136:139], v38, s[88:91], 0 offen offset:3072
L_nopf:
    s_cmp_lg_u32 s4, 7
    s_cbranch_scc1 L_noq2
L_w5:
    ds_read_b32 v1, v8 offset:0
    s_waitcnt lgkmcnt(0)
    v_cmp_gt_i32 vcc, 10, v1
    s_cbranch_vccz L_wd6
    s_branch L_w5
L_wd6:
L_qp:
    buffer_load_dwordx4 v[20:23], v3, s[20:23], s27 offen sc1
    s_waitcnt vmcnt(0)
    v_xor_b32 v20, s80, v20
    v_xor_b32 v21, s81, v21
    v_xor_b32 v22, s82, v22
    v_xor_b32 v23, s83, v23
    v_or3_b32 v1, v20, v21, v22
    v_or_b32 v1, v1, v23
    v_and_b32 v1, 0xff, v1
    v_cmp_ne_u32 vcc, 0, v1
    s_cbranch_vccnz L_qp
    v_perm_b32 v20, v21, v20, s26
    v_perm_b32 v21, v23, v22, s26
    v_mov_b32 v1, 1
    ds_write_b64 v14, v[20:21]
    ds_write_b32 v8, v1 offset:288
L_noq2:
L_w7:
    ds_read_b32 v1, v8 offset:288
    s_waitcnt lgkmcnt(0)
    v_cmp_gt_i32 vcc, 1, v1
    s_cbranch_vccz L_wd8
    s_branch L_w7
L_wd8:
    ds_read_b128 v[40:43], v13 offset:0
    ds_read_b128 v[44:47], v13 offset:64
    ds_read_b128 v[48:51], v13 offset:128
    ds_read_b128 v[52:55], v13 offset:192
    ds_read_b128 v[56:59], v13 offset:256
    ds_read_b128 v[60:63], v13 offset:320
    ds_read_b128 v[64:67], v13 offset:384
    ds_read_b128 v[68:71], v13 offset:448
    s_waitcnt lgkmcnt(0)
    v_mfma_f32_16x16x32_bf16 v[16:19], v[72:75], v[40:43], 0
    v_mfma_f32_16x16x32_bf16 v[20:23], v[76:79], v[40:43], 0
    v_mfma_f32_16x16x32_bf16 v[16:19], v[80:83], v[44:47], v[16:19]
    v_mfma_f32_16x16x32_bf16 v[20:23], v[84:87], v[44:47], v[20:23]
    v_mfma_f32_16x16x32_bf16 v[16:19], v[88:91], v[48:51], v[16:19]
    v_mfma_f32_16x16x32_bf16 v[20:23], v[92:95], v[48:51], v[20:23]
    v_mfma_f32_16x16x32_bf16 v[16:19], v[96:99], v[52:55], v[16:19]
    v_mfma_f32_16x16x32_bf16 v[20:23], v[100:103], v[52:55], v[20:23]
    v_mfma_f32_16x16x32_bf16 v[16:19], v[104:107], v[56:59], v[16:19]
    v_mfma_f32_16x16x32_bf16 v[20:23], v[108:111], v[56:59], v[20:23]
    v_mfma_f32_16x16x32_bf16 v[16:19], v[112:115], v[60:63], v[16:19]
    v_mfma_f32_16x16x32_bf16 v[20:23], v[116:119], v[60:63], v[20:23]
    v_mfma_f32_16x16x32_bf16 v[16:19], v[120:123], v[64:67], v[16:19]
    v_mfma_f32_16x16x32_bf16 v[20:23], v[124:127], v[64:67], v[20:23]
    v_mfma_f32_16x16x32_bf16 v[16:19], v[128:131], v[68:71], v[16:19]
    v_mfma_f32_16x16x32_bf16 v[20:23], v[132:135], v[68:71], v[20:23]
    s_branch L_k_tail
L_k_loop:
L_w9:
    ds_read_b32 v1, v8 offset:0
    s_waitcnt lgkmcnt(0)
    v_cmp_gt_i32 vcc, s29, v1
    s_cbranch_vccz L_wd10
    s_branch L_w9
L_wd10:
    ds_read_b128 v[72:75], v164 offset:0
    ds_read_b128 v[76:79], v164 offset:8192
    ds_read_b128 v[80:83], v165 offset:0
    ds_read_b128 v[84:87], v165 offset:8192
    ds_read_b128 v[88:91], v166 offset:0
    ds_read_b128 v[92:95], v166 offset:8192
    ds_read_b128 v[96:99], v167 offset:0
    ds_read_b128 v[100:103], v167 offset:8192
    s_waitcnt lgkmcnt(7)
    v_mfma_f32_16x16x32_bf16 v[16:19], v[72:75], v[40:43], 0
    s_waitcnt lgkmcnt(6)
    v_mfma_f32_16x16x32_bf16 v[20:23], v[76:79], v[40:43], 0
    s_waitcnt lgkmcnt(5)
    v_mfma_f32_16x16x32_bf16 v[16:19], v[80:83], v[44:47], v[16:19]
    s_waitcnt lgkmcnt(4)
    v_mfma_f32_16x16x32_bf16 v[20:23], v[84:87], v[44:47], v[20:23]
    s_waitcnt lgkmcnt(3)
    v_mfma_f32_16x16x32_bf16 v[16:19], v[88:91], v[48:51], v[16:19]
    s_waitcnt lgkmcnt(2)
    v_mfma_f32_16x16x32_bf16 v[20:23], v[92:95], v[48:51], v[20:23]
    s_waitcnt lgkmcnt(1)
    v_mfma_f32_16x16x32_bf16 v[16:19], v[96:99], v[52:55], v[16:19]
    s_waitcnt lgkmcnt(0)
    v_mfma_f32_16x16x32_bf16 v[20:23], v[100:103], v[52:55], v[20:23]
    ds_read_b128 v[72:75], v164 offset:256
    ds_read_b128 v[76:79], v164 offset:8448
    ds_read_b128 v[80:83], v165 offset:256
    ds_read_b128 v[84:87], v165 offset:8448
    ds_read_b128 v[88:91], v166 offset:256
    ds_read_b128 v[92:95], v166 offset:8448
    ds_read_b128 v[96:99], v167 offset:256
    ds_read_b128 v[100:103], v167 offset:8448
    s_waitcnt lgkmcnt(7)
    v_mfma_f32_16x16x32_bf16 v[16:19], v[72:75], v[56:59], v[16:19]
    s_waitcnt lgkmcnt(6)
    v_mfma_f32_16x16x32_bf16 v[20:23], v[76:79], v[56:59], v[20:23]
    s_waitcnt lgkmcnt(5)
    v_mfma_f32_16x16x32_bf16 v[16:19], v[80:83], v[60:63], v[16:19]
    s_waitcnt lgkmcnt(4)
    v_mfma_f32_16x16x32_bf16 v[20:23], v[84:87], v[60:63], v[20:23]
    s_waitcnt lgkmcnt(3)
    v_mfma_f32_16x16x32_bf16 v[16:19], v[88:91], v[64:67], v[16:19]
    s_waitcnt lgkmcnt(2)
    v_mfma_f32_16x16x32_bf16 v[20:23], v[92:95], v[64:67], v[20:23]
    s_waitcnt lgkmcnt(1)
    v_mfma_f32_16x16x32_bf16 v[16:19], v[96:99], v[68:71], v[16:19]
    s_waitcnt lgkmcnt(0)
    v_mfma_f32_16x16x32_bf16 v[20:23], v[100:103], v[68:71], v[20:23]
L_k_tail:
    s_add_u32 s29, s29, 8
    s_sub_u32 s25, s29, 1
    s_min_u32 s25, s25, 64
    v_mov_b32 v1, s25
    s_mov_b64 exec, 1
    ds_write_b32 v9, v1 offset:256
    s_mov_b64 exec, -1
    s_nop 3
    s_mov_b64 exec, s[30:31]
    v_cvt_pk_bf16_f32 v160, v16, v17
    v_cvt_pk_bf16_f32 v161, v18, v19
    v_cvt_pk_bf16_f32 v162, v20, v21
    v_cvt_pk_bf16_f32 v163, v22, v23
    s_mov_b64 exec, -1
    s_lshl_b64 s[30:31], s[30:31], 1
    s_add_u32 s28, s28, 1
    s_cmp_ge_u32 s6, 28
    s_cbranch_scc1 L_k_noev
    s_cmp_eq_u32 s28, 2
    s_cbranch_scc1 L_ev1_1
    s_cmp_eq_u32 s28, 3
    s_cbranch_scc1 L_ev1_2
    s_cmp_eq_u32 s28, 4
    s_cbranch_scc1 L_ev1_3
    s_cmp_eq_u32 s28, 5
    s_cbranch_scc1 L_ev1_4
    s_cmp_eq_u32 s28, 6
    s_cbranch_scc1 L_ev2
    s_cmp_eq_u32 s28, 7
    s_cbranch_scc1 L_ev3
L_k_noev:
    s_cmp_lt_u32 s28, 8
    s_cbranch_scc1 L_k_loop
    s_branch L_mid
L_ev1_1:
    s_mov_b32 s12, s44
    s_mov_b32 s13, s45
    s_mov_b32 s14, 1605632
    s_mov_b32 s15, 0x20000
    v_lshrrev_b32 v2, 4, v0
    v_and_b32 v3, 7, v0
    v_mul_u32_u24 v2, 50176, v2
    v_lshl_add_u32 v2, v3, 4, v2
    s_mul_i32 s24, s4, 200704
    s_lshl_b32 s25, s6, 7
    s_add_u32 s24, s24, s25
    s_mov_b32 s27, s24
    s_mov_b32 exec_lo, 0x00ff00ff
    s_mov_b32 exec_hi, 0x00ff00ff
    buffer_load_dwordx4 v[104:107], v2, s[12:15], s27 offen
    s_add_u32 s27, s27, 3584
    buffer_load_dwordx4 v[108:111], v2, s[12:15], s27 offen
    s_add_u32 s27, s27, 3584
    buffer_load_dwordx4 v[112:115], v2, s[12:15], s27 offen
    s_add_u32 s27, s27, 3584
    buffer_load_dwordx4 v[116:119], v2, s[12:15], s27 offen
    s_add_u32 s27, s27, 3584
    buffer_load_dwordx4 v[120:123], v2, s[12:15], s27 offen
    s_add_u32 s27, s27, 3584
    buffer_load_dwordx4 v[124:127], v2, s[12:15], s27 offen
    s_add_u32 s27, s27, 3584
    buffer_load_dwordx4 v[128:131], v2, s[12:15], s27 offen
    s_add_u32 s27, s27, 3584
    s_mov_b64 exec, -1
    s_branch L_k_loop
L_ev1_2:
    s_mov_b32 exec_lo, 0x00ff00ff
    s_mov_b32 exec_hi, 0x00ff00ff
    buffer_load_dwordx4 v[132:135], v2, s[12:15], s27 offen
    s_add_u32 s27, s27, 3584
    buffer_load_dwordx4 v[136:139], v2, s[12:15], s27 offen
    s_add_u32 s27, s27, 3584
    buffer_load_dwordx4 v[140:143], v2, s[12:15], s27 offen
    s_add_u32 s27, s27, 3584
    buffer_load_dwordx4 v[144:147], v2, s[12:15], s27 offen
    s_add_u32 s27, s27, 3584
    buffer_load_dwordx4 v[148:151], v2, s[12:15], s27 offen
    s_add_u32 s27, s27, 3584
    buffer_load_dwordx4 v[152:155], v2, s[12:15], s27 offen
    s_add_u32 s27, s27, 3584
    buffer_load_dwordx4 v[156:159], v2, s[12:15], s27 offen
    s_add_u32 s27, s27, 3584
    s_mov_b64 exec, -1
    s_branch L_k_loop
L_ev1_3:
    s_mov_b32 s12, s46
    s_mov_b32 s13, s47
    s_mov_b32 exec_lo, 0xff00ff00
    s_mov_b32 exec_hi, 0xff00ff00
    buffer_load_dwordx4 v[104:107], v2, s[12:15], s24 offen
    s_add_u32 s24, s24, 3584
    buffer_load_dwordx4 v[108:111], v2, s[12:15], s24 offen
    s_add_u32 s24, s24, 3584
    buffer_load_dwordx4 v[112:115], v2, s[12:15], s24 offen
    s_add_u32 s24, s24, 3584
    buffer_load_dwordx4 v[116:119], v2, s[12:15], s24 offen
    s_add_u32 s24, s24, 3584
    buffer_load_dwordx4 v[120:123], v2, s[12:15], s24 offen
    s_add_u32 s24, s24, 3584
    buffer_load_dwordx4 v[124:127], v2, s[12:15], s24 offen
    s_add_u32 s24, s24, 3584
    buffer_load_dwordx4 v[128:131], v2, s[12:15], s24 offen
    s_add_u32 s24, s24, 3584
    s_mov_b64 exec, -1
    s_branch L_k_loop
L_ev1_4:
    s_mov_b32 exec_lo, 0xff00ff00
    s_mov_b32 exec_hi, 0xff00ff00
    buffer_load_dwordx4 v[132:135], v2, s[12:15], s24 offen
    s_add_u32 s24, s24, 3584
    buffer_load_dwordx4 v[136:139], v2, s[12:15], s24 offen
    s_add_u32 s24, s24, 3584
    buffer_load_dwordx4 v[140:143], v2, s[12:15], s24 offen
    s_add_u32 s24, s24, 3584
    buffer_load_dwordx4 v[144:147], v2, s[12:15], s24 offen
    s_add_u32 s24, s24, 3584
    buffer_load_dwordx4 v[148:151], v2, s[12:15], s24 offen
    s_add_u32 s24, s24, 3584
    buffer_load_dwordx4 v[152:155], v2, s[12:15], s24 offen
    s_add_u32 s24, s24, 3584
    buffer_load_dwordx4 v[156:159], v2, s[12:15], s24 offen
    s_add_u32 s24, s24, 3584
    s_mov_b64 exec, -1
    s_branch L_k_loop
L_ev2:
    v_lshrrev_b32 v2, 4, v0
    s_mul_i32 s24, s5, 960
    s_mul_i32 s25, s4, 112
    s_add_u32 s24, s24, s25
    s_add_u32 s24, s24, 152576
    v_mul_u32_u24 v2, 28, v2
    v_add_u32 v2, s24, v2
    ds_read_b32 v24, v2 offset:0
    ds_read_b32 v25, v2 offset:4
    ds_read_b32 v26, v2 offset:8
    ds_read_b32 v27, v2 offset:12
    ds_read_b32 v28, v2 offset:16
    ds_read_b32 v29, v2 offset:20
    ds_read_b32 v30, v2 offset:24
    s_mov_b32 s24, 0x01000100
    s_mov_b32 s25, 0x03020302
    s_waitcnt lgkmcnt(0)
    v_perm_b32 v37, v30, v30, s25
    v_perm_b32 v36, v30, v30, s24
    v_perm_b32 v35, v29, v29, s25
    v_perm_b32 v34, v29, v29, s24
    v_perm_b32 v33, v28, v28, s25
    v_perm_b32 v32, v28, v28, s24
    v_perm_b32 v31, v27, v27, s25
    v_perm_b32 v30, v27, v27, s24
    v_perm_b32 v29, v26, v26, s25
    v_perm_b32 v28, v26, v26, s24
    v_perm_b32 v27, v25, v25, s25
    v_perm_b32 v26, v25, v25, s24
    v_perm_b32 v25, v24, v24, s25
    v_perm_b32 v24, v24, v24, s24
    s_waitcnt vmcnt(0)
    v_and_b32 v72, v4, v24
    v_and_b32 v73, v5, v24
    v_and_b32 v74, v6, v24
    v_and_b32 v75, v7, v24
    s_nop 1
    v_mfma_f32_16x16x32_bf16 v[16:19], v[104:107], v[72:75], 0
    v_and_b32 v76, v4, v25
    v_and_b32 v77, v5, v25
    v_and_b32 v78, v6, v25
    v_and_b32 v79, v7, v25
    s_nop 1
    v_mfma_f32_16x16x32_bf16 v[16:19], v[108:111], v[76:79], v[16:19]
    v_and_b32 v72, v4, v26
    v_and_b32 v73, v5, v26
    v_and_b32 v74, v6, v26
    v_and_b32 v75, v7, v26
    s_nop 1
    v_mfma_f32_16x16x32_bf16 v[16:19], v[112:115], v[72:75], v[16:19]
    v_and_b32 v76, v4, v27
    v_and_b32 v77, v5, v27
    v_and_b32 v78, v6, v27
    v_and_b32 v79, v7, v27
    s_nop 1
    v_mfma_f32_16x16x32_bf16 v[16:19], v[116:119], v[76:79], v[16:19]
    v_and_b32 v72, v4, v28
    v_and_b32 v73, v5, v28
    v_and_b32 v74, v6, v28
    v_and_b32 v75, v7, v28
    s_nop 1
    v_mfma_f32_16x16x32_bf16 v[16:19], v[120:123], v[72:75], v[16:19]
    v_and_b32 v76, v4, v29
    v_and_b32 v77, v5, v29
    v_and_b32 v78, v6, v29
    v_and_b32 v79, v7, v29
    s_nop 1
    v_mfma_f32_16x16x32_bf16 v[16:19], v[124:127], v[76:79], v[16:19]
    v_and_b32 v72, v4, v30
    v_and_b32 v73, v5, v30
    v_and_b32 v74, v6, v30
    v_and_b32 v75, v7, v30
    s_nop 1
    v_mfma_f32_16x16x32_bf16 v[16:19], v[128:131], v[72:75], v[16:19]
    v_and_b32 v76, v4, v31
    v_and_b32 v77, v5, v31
    v_and_b32 v78, v6, v31
    v_and_b32 v79, v7, v31
    s_nop 1
    v_mfma_f32_16x16x32_bf16 v[16:19], v[132:135], v[76:79], v[16:19]
    v_and_b32 v72, v4, v32
    v_and_b32 v73, v5, v32
    v_and_b32 v74, v6, v32
    v_and_b32 v75, v7, v32
    s_nop 1
    v_mfma_f32_16x16x32_bf16 v[16:19], v[136:139], v[72:75], v[16:19]
    v_and_b32 v76, v4, v33
    v_and_b32 v77, v5, v33
    v_and_b32 v78, v6, v33
    v_and_b32 v79, v7, v33
    s_nop 1
    v_mfma_f32_16x16x32_bf16 v[16:19], v[140:143], v[76:79], v[16:19]
    v_and_b32 v72, v4, v34
    v_and_b32 v73, v5, v34
    v_and_b32 v74, v6, v34
    v_and_b32 v75, v7, v34
    s_nop 1
    v_mfma_f32_16x16x32_bf16 v[16:19], v[144:147], v[72:75], v[16:19]
    v_and_b32 v76, v4, v35
    v_and_b32 v77, v5, v35
    v_and_b32 v78, v6, v35
    v_and_b32 v79, v7, v35
    s_nop 1
    v_mfma_f32_16x16x32_bf16 v[16:19], v[148:151], v[76:79], v[16:19]
    v_and_b32 v72, v4, v36
    v_and_b32 v73, v5, v36
    v_and_b32 v74, v6, v36
    v_and_b32 v75, v7, v36
    s_nop 1
    v_mfma_f32_16x16x32_bf16 v[16:19], v[152:155], v[72:75], v[16:19]
    v_and_b32 v76, v4, v37
    v_and_b32 v77, v5, v37
    v_and_b32 v78, v6, v37
    v_and_b32 v79, v7, v37
    s_nop 1
    v_mfma_f32_16x16x32_bf16 v[16:19], v[156:159], v[76:79], v[16:19]
    s_mov_b32 s12, s48
    s_mov_b32 s13, s49
    s_mov_b32 s14, 1605632
    s_mov_b32 s15, 0x20000
    v_lshrrev_b32 v2, 3, v0
    v_and_b32 v3, 7, v0
    v_mul_u32_u24 v2, 896, v2
    v_lshl_add_u32 v38, v3, 4, v2
    s_and_b32 s24, s6, 3
    s_lshl_b32 s24, s24, 3
    s_add_u32 s24, s24, s4
    s_mul_i32 s24, s24, 50176
    s_lshr_b32 s25, s6, 2
    s_lshl_b32 s25, s25, 7
    s_add_u32 s62, s24, s25
    ds_write_b128 v11, v[16:19] offset:8192
    v_mov_b32 v1, 2
    s_mov_b64 exec, 1
    ds_write_b32 v9, v1 offset:320
    s_mov_b64 exec, -1
    buffer_load_dwordx4 v[104:107], v38, s[12:15], s62 offen
    s_add_u32 s62, s62, 7168
    buffer_load_dwordx4 v[108:111], v38, s[12:15], s62 offen
    s_add_u32 s62, s62, 7168
    buffer_load_dwordx4 v[112:115], v38, s[12:15], s62 offen
    s_add_u32 s62, s62, 7168
    buffer_load_dwordx4 v[116:119], v38, s[12:15], s62 offen
    s_add_u32 s62, s62, 7168
    s_branch L_k_loop
L_ev3:
    buffer_load_dwordx4 v[120:123], v38, s[12:15], s62 offen
    s_add_u32 s62, s62, 7168
    buffer_load_dwordx4 v[124:127], v38, s[12:15], s62 offen
    s_add_u32 s62, s62, 7168
    buffer_load_dwordx4 v[128:131], v38, s[12:15], s62 offen
    s_add_u32 s62, s62, 7168
    s_cmp_lg_u32 s4, 0
    s_cbranch_scc1 L_k_loop
L_w11:
    ds_read_b32 v1, v8 offset:320
    s_waitcnt lgkmcnt(0)
    v_cmp_gt_i32 vcc, 2, v1
    s_cbranch_vccz L_wd12
    s_branch L_w11
L_wd12:
    ds_read_b128 v[72:75], v10 offset:8192
    ds_read_b128 v[76:79], v10 offset:9216
    ds_read_b128 v[80:83], v10 offset:10240
    ds_read_b128 v[84:87], v10 offset:11264
    ds_read_b128 v[88:91], v10 offset:12288
    ds_read_b128 v[92:95], v10 offset:13312
    ds_read_b128 v[96:99], v10 offset:14336
    ds_read_b128 v[100:103], v10 offset:15360
    s_waitcnt lgkmcnt(0)
    v_add_f32 v72, v72, v76
    v_add_f32 v73, v73, v77
    v_add_f32 v74, v74, v78
    v_add_f32 v75, v75, v79
    v_add_f32 v72, v72, v80
    v_add_f32 v73, v73, v81
    v_add_f32 v74, v74, v82
    v_add_f32 v75, v75, v83
    v_add_f32 v72, v72, v84
    v_add_f32 v73, v73, v85
    v_add_f32 v74, v74, v86
    v_add_f32 v75, v75, v87
    v_add_f32 v72, v72, v88
    v_add_f32 v73, v73, v89
    v_add_f32 v74, v74, v90
    v_add_f32 v75, v75, v91
    v_add_f32 v72, v72, v92
    v_add_f32 v73, v73, v93
    v_add_f32 v74, v74, v94
    v_add_f32 v75, v75, v95
    v_add_f32 v72, v72, v96
    v_add_f32 v73, v73, v97
    v_add_f32 v74, v74, v98
    v_add_f32 v75, v75, v99
    v_add_f32 v72, v72, v100
    v_add_f32 v73, v73, v101
    v_add_f32 v74, v74, v102
    v_add_f32 v75, v75, v103
    v_lshrrev_b32 v2, 4, v0
    v_and_b32 v2, 1, v2
    v_and_b32 v3, 7, v0
    v_lshlrev_b32 v3, 2, v3
    v_lshl_add_u32 v3, v2, 7, v3
    v_add_u32 v3, 152064, v3
    v_cvt_pk_bf16_f32 v72, v72, v72
    v_and_b32 v72, 0xffff0000, v72
    v_mov_b32 v76, v72
    s_nop 1
    v_permlane32_swap_b32 v72, v76
    s_nop 1
    v_mul_f32 v77, v72, v72
    v_mul_f32 v77, 1027024659, v77
    v_fma_f32 v77, v77, v72, v72
    v_mul_f32 v77, 3222493025, v77
    v_exp_f32 v77, v77
    s_nop 0
    v_add_f32 v77, 1.0, v77
    v_rcp_f32 v77, v77
    s_nop 0
    v_mul_f32 v72, v72, v77
    v_cvt_pk_bf16_f32 v72, v72, v72
    v_and_b32 v72, 0xffff0000, v72
    v_mul_f32 v72, v72, v76
    v_cvt_pk_bf16_f32 v72, v72, v72
    v_and_b32 v72, 0xffff0000, v72
    v_cvt_pk_bf16_f32 v73, v73, v73
    v_and_b32 v73, 0xffff0000, v73
    v_mov_b32 v76, v73
    s_nop 1
    v_permlane32_swap_b32 v73, v76
    s_nop 1
    v_mul_f32 v77, v73, v73
    v_mul_f32 v77, 1027024659, v77
    v_fma_f32 v77, v77, v73, v73
    v_mul_f32 v77, 3222493025, v77
    v_exp_f32 v77, v77
    s_nop 0
    v_add_f32 v77, 1.0, v77
    v_rcp_f32 v77, v77
    s_nop 0
    v_mul_f32 v73, v73, v77
    v_cvt_pk_bf16_f32 v73, v73, v73
    v_and_b32 v73, 0xffff0000, v73
    v_mul_f32 v73, v73, v76
    v_cvt_pk_bf16_f32 v73, v73, v73
    v_and_b32 v73, 0xffff0000, v73
    v_cvt_pk_bf16_f32 v74, v74, v74
    v_and_b32 v74, 0xffff0000, v74
    v_mov_b32 v76, v74
    s_nop 1
    v_permlane32_swap_b32 v74, v76
    s_nop 1
    v_mul_f32 v77, v74, v74
    v_mul_f32 v77, 1027024659, v77
    v_fma_f32 v77, v77, v74, v74
    v_mul_f32 v77, 3222493025, v77
    v_exp_f32 v77, v77
    s_nop 0
    v_add_f32 v77, 1.0, v77
    v_rcp_f32 v77, v77
    s_nop 0
    v_mul_f32 v74, v74, v77
    v_cvt_pk_bf16_f32 v74, v74, v74
    v_and_b32 v74, 0xffff0000, v74
    v_mul_f32 v74, v74, v76
    v_cvt_pk_bf16_f32 v74, v74, v74
    v_and_b32 v74, 0xffff0000, v74
    v_cvt_pk_bf16_f32 v75, v75, v75
    v_and_b32 v75, 0xffff0000, v75
    v_mov_b32 v76, v75
    s_nop 1
    v_permlane32_swap_b32 v75, v76
    s_nop 1
    v_mul_f32 v77, v75, v75
    v_mul_f32 v77, 1027024659, v77
    v_fma_f32 v77, v77, v75, v75
    v_mul_f32 v77, 3222493025, v77
    v_exp_f32 v77, v77
    s_nop 0
    v_add_f32 v77, 1.0, v77
    v_rcp_f32 v77, v77
    s_nop 0
    v_mul_f32 v75, v75, v77
    v_cvt_pk_bf16_f32 v75, v75, v75
    v_and_b32 v75, 0xffff0000, v75
    v_mul_f32 v75, v75, v76
    v_cvt_pk_bf16_f32 v75, v75, v75
    v_and_b32 v75, 0xffff0000, v75
    s_mov_b32 exec_lo, 0x00ff00ff
    s_mov_b32 exec_hi, 0
    ds_write_b32 v3, v72 offset:0
    ds_write_b32 v3, v73 offset:32
    ds_write_b32 v3, v74 offset:64
    ds_write_b32 v3, v75 offset:96
    s_mov_b64 exec, -1
    v_lshlrev_b32 v3, 2, v0
    v_add_u32 v2, 152064, v3
    s_waitcnt lgkmcnt(0)
    ds_read_b32 v2, v2
    s_lshl_b32 s24, s7, 8
    s_add_u32 s24, s24, 196608
    v_bfe_u32 v1, v0, 0, 2
    v_lshlrev_b32 v1, 3, v1
    v_bfe_u32 v1, s84, v1, 8
    s_waitcnt lgkmcnt(0)
    v_or_b32 v2, v2, v1
    buffer_store_dword v2, v3, s[20:23], s24 offen sc1
    s_branch L_k_loop
L_mid:
    v_lshlrev_b32 v24, 16, v160
    v_and_b32 v25, 0xffff0000, v160
    v_lshlrev_b32 v26, 16, v161
    v_and_b32 v27, 0xffff0000, v161
    v_lshlrev_b32 v28, 16, v162
    v_and_b32 v29, 0xffff0000, v162
    v_lshlrev_b32 v30, 16, v163
    v_and_b32 v31, 0xffff0000, v163
    v_max3_f32 v3, v24, v25, v26
    v_max3_f32 v3, v3, v27, v28
    v_max3_f32 v3, v3, v29, v30
    v_max_f32 v3, v3, v31
    s_nop 1
    v_max_f32_dpp v3, v3, v3 quad_perm:[1,0,3,2] row_mask:0xf bank_mask:0xf
    s_nop 1
    v_max_f32_dpp v3, v3, v3 quad_perm:[2,3,0,1] row_mask:0xf bank_mask:0xf
    s_nop 1
    v_max_f32_dpp v3, v3, v3 row_half_mirror row_mask:0xf bank_mask:0xf
    s_nop 1
    v_max_f32_dpp v3, v3, v3 row_mirror row_mask:0xf bank_mask:0xf
    v_mov_b32 v2, v3
    s_nop 1
    v_permlane16_swap_b32 v3, v2
    s_nop 1
    v_max_f32 v3, v3, v2
    v_mov_b32 v2, v3
    s_nop 1
    v_permlane32_swap_b32 v3, v2
    s_nop 1
    v_max_f32 v3, v3, v2
    s_mov_b64 exec, 1
    ds_write_b32 v9, v3 offset:384
    s_mov_b64 exec, -1
    v_mov_b32 v1, 3
    s_mov_b64 exec, 1
    ds_write_b32 v9, v1 offset:320
    s_mov_b64 exec, -1
    s_cmp_lg_u32 s4, 2
    s_cbranch_scc1 L_noh
    s_cmp_ge_u32 s6, 28
    s_cbranch_scc1 L_noh
    v_lshlrev_b32 v2, 4, v0
    v_min_u32 v3, 47, v0
    v_lshlrev_b32 v3, 4, v3
    s_and_b32 s25, s6, 3
    s_mul_i32 s25, s25, 1792
    s_lshl_b32 s24, s5, 13
    s_add_u32 s24, s24, s25
    s_add_u32 s24, s24, 196608
L_hp:
    buffer_load_dwordx4 v[40:43], v2, s[20:23], s24 offen sc1
    buffer_load_dwordx4 v[44:47], v3, s[20:23], s24 offen offset:1024 sc1
    s_waitcnt vmcnt(0)
    v_xor_b32 v40, s80, v40
    v_xor_b32 v41, s81, v41
    v_xor_b32 v42, s82, v42
    v_xor_b32 v43, s83, v43
    v_xor_b32 v44, s80, v44
    v_xor_b32 v45, s81, v45
    v_xor_b32 v46, s82, v46
    v_xor_b32 v47, s83, v47
    v_or3_b32 v1, v40, v41, v42
    v_or3_b32 v1, v1, v43, v44
    v_or3_b32 v1, v1, v45, v46
    v_or_b32 v1, v1, v47
    v_and_b32 v1, 0xff, v1
    v_cmp_ne_u32 vcc, 0, v1
    s_cbranch_vccnz L_hp
    ds_write_b128 v10, v[40:43] offset:4096
    ds_write_b128 v10, v[44:47] offset:5120
L_noh:
    v_lshrrev_b32 v2, 4, v0
    v_lshlrev_b32 v13, 4, v2
    v_add_u32 v13, 131072, v13
    v_and_b32 v3, 7, v0
    v_lshl_add_u32 v12, v3, 9, v13
    s_lshl_b32 s25, s4, 6
    v_add_u32 v12, s25, v12
L_w13:
    ds_read_b32 v1, v8 offset:320
    s_waitcnt lgkmcnt(0)
    v_cmp_gt_i32 vcc, 3, v1
    s_cbranch_vccz L_wd14
    s_branch L_w13
L_wd14:
    ds_read_b32 v3, v8 offset:384
    s_waitcnt lgkmcnt(0)
    s_nop 1
    v_max_f32_dpp v3, v3, v3 quad_perm:[1,0,3,2] row_mask:0xf bank_mask:0xf
    s_nop 1
    v_max_f32_dpp v3, v3, v3 quad_perm:[2,3,0,1] row_mask:0xf bank_mask:0xf
    s_nop 1
    v_max_f32_dpp v3, v3, v3 row_half_mirror row_mask:0xf bank_mask:0xf
    s_mov_b32 s26, 1035512379
    v_mul_f32 v2, s26, v3
    v_readfirstlane_b32 s56, v3
    v_fma_f32 v24, v24, s26, -v2
    v_fma_f32 v25, v25, s26, -v2
    v_fma_f32 v26, v26, s26, -v2
    v_fma_f32 v27, v27, s26, -v2
    v_fma_f32 v28, v28, s26, -v2
    v_fma_f32 v29, v29, s26, -v2
    v_fma_f32 v30, v30, s26, -v2
    v_fma_f32 v31, v31, s26, -v2
    v_exp_f32 v24, v24
    v_exp_f32 v25, v25
    v_exp_f32 v26, v26
    v_exp_f32 v27, v27
    v_exp_f32 v28, v28
    v_exp_f32 v29, v29
    v_exp_f32 v30, v30
    v_exp_f32 v31, v31
    v_add_f32 v3, v24, v25
    v_add_f32 v3, v3, v26
    v_add_f32 v3, v3, v27
    v_add_f32 v3, v3, v28
    v_add_f32 v3, v3, v29
    v_add_f32 v3, v3, v30
    v_add_f32 v3, v3, v31
    v_cvt_pk_bf16_f32 v32, v24, v25
    v_cvt_pk_bf16_f32 v33, v26, v27
    v_cvt_pk_bf16_f32 v34, v28, v29
    v_cvt_pk_bf16_f32 v35, v30, v31
    s_mov_b32 exec_lo, 0x00ff00ff
    s_mov_b32 exec_hi, 0x00ff00ff
    ds_write_b128 v12, v[32:35]
    s_mov_b64 exec, -1
    s_nop 1
    v_add_f32_dpp v3, v3, v3 quad_perm:[1,0,3,2] row_mask:0xf bank_mask:0xf
    s_nop 1
    v_add_f32_dpp v3, v3, v3 quad_perm:[2,3,0,1] row_mask:0xf bank_mask:0xf
    s_nop 1
    v_add_f32_dpp v3, v3, v3 row_half_mirror row_mask:0xf bank_mask:0xf
    s_nop 1
    v_add_f32_dpp v3, v3, v3 row_mirror row_mask:0xf bank_mask:0xf
    v_mov_b32 v2, v3
    s_nop 1
    v_permlane16_swap_b32 v3, v2
    s_nop 1
    v_add_f32 v3, v3, v2
    v_mov_b32 v2, v3
    s_nop 1
    v_permlane32_swap_b32 v3, v2
    s_nop 1
    v_add_f32 v3, v3, v2
    v_mul_f32 v3, 0.5, v3
    s_mov_b64 exec, 1
    ds_write_b32 v9, v3 offset:448
    s_mov_b64 exec, -1
    v_mov_b32 v1, 4
    s_mov_b64 exec, 1
    ds_write_b32 v9, v1 offset:320
    s_mov_b64 exec, -1
    v_bfe_u32 v3, v0, 2, 4
    v_and_b32 v1, 7, v3
    s_lshl_b32 s25, s4, 1
    v_xor_b32 v1, s25, v1
    v_lshlrev_b32 v1, 5, v1
    v_lshl_add_u32 v1, v3, 9, v1
    v_and_b32 v3, 3, v0
    v_lshl_add_u32 v11, v3, 3, v1
    v_xor_b32 v12, 32, v11
L_w15:
    ds_read_b32 v1, v8 offset:320
    s_waitcnt lgkmcnt(0)
    v_cmp_gt_i32 vcc, 4, v1
    s_cbranch_vccz L_wd16
    s_branch L_w15
L_wd16:
    ds_read_b32 v3, v8 offset:448
    s_waitcnt lgkmcnt(0)
    s_nop 1
    v_add_f32_dpp v3, v3, v3 quad_perm:[1,0,3,2] row_mask:0xf bank_mask:0xf
    s_nop 1
    v_add_f32_dpp v3, v3, v3 quad_perm:[2,3,0,1] row_mask:0xf bank_mask:0xf
    s_nop 1
    v_add_f32_dpp v3, v3, v3 row_half_mirror row_mask:0xf bank_mask:0xf
    s_nop 0
    v_readfirstlane_b32 s57, v3
    s_cmp_lg_u32 s4, 3
    s_cbranch_scc1 L_noml
    v_mov_b32 v24, s56
    v_mov_b32 v25, v3
    v_mov_b32 v26, 0
    v_mov_b32 v27, 0
    v_mov_b32 v1, 1792
    v_mov_b32_sdwa v24, s80 dst_sel:BYTE_0 dst_unused:UNUSED_PRESERVE src0_sel:BYTE_0
    v_mov_b32_sdwa v25, s81 dst_sel:BYTE_0 dst_unused:UNUSED_PRESERVE src0_sel:BYTE_0
    v_mov_b32_sdwa v26, s82 dst_sel:BYTE_0 dst_unused:UNUSED_PRESERVE src0_sel:BYTE_0
    v_mov_b32_sdwa v27, s83 dst_sel:BYTE_0 dst_unused:UNUSED_PRESERVE src0_sel:BYTE_0
    s_nop 0
    s_mov_b64 exec, 1
    buffer_store_dwordx4 v[24:27], v1, s[16:19], 0 offen sc1
    s_mov_b64 exec, -1
L_noml:
    s_mov_b32 s28, 64
    s_cmp_ge_u32 s6, 28
    s_cbranch_scc1 L_noy
    v_lshrrev_b32 v2, 3, v0
    s_mul_i32 s25, s4, 224
    s_add_u32 s25, s25, 139264
    v_lshl_add_u32 v2, v2, 2, s25
    ds_read_b32 v40, v2 offset:0
    ds_read_b32 v41, v2 offset:32
    ds_read_b32 v42, v2 offset:64
    ds_read_b32 v43, v2 offset:96
    ds_read_b32 v44, v2 offset:128
    ds_read_b32 v45, v2 offset:160
    ds_read_b32 v46, v2 offset:192
    s_waitcnt vmcnt(0) lgkmcnt(0)
    v_lshlrev_b32 v24, 16, v104
    v_and_b32 v25, 0xffff0000, v104
    v_lshlrev_b32 v26, 16, v105
    v_and_b32 v27, 0xffff0000, v105
    v_lshlrev_b32 v28, 16, v106
    v_and_b32 v29, 0xffff0000, v106
    v_lshlrev_b32 v30, 16, v107
    v_and_b32 v31, 0xffff0000, v107
    v_mul_f32 v16, v24, v40
    v_mul_f32 v17, v25, v40
    v_mul_f32 v18, v26, v40
    v_mul_f32 v19, v27, v40
    v_mul_f32 v20, v28, v40
    v_mul_f32 v21, v29, v40
    v_mul_f32 v22, v30, v40
    v_mul_f32 v23, v31, v40
    v_lshlrev_b32 v24, 16, v108
    v_and_b32 v25, 0xffff0000, v108
    v_lshlrev_b32 v26, 16, v109
    v_and_b32 v27, 0xffff0000, v109
    v_lshlrev_b32 v28, 16, v110
    v_and_b32 v29, 0xffff0000, v110
    v_lshlrev_b32 v30, 16, v111
    v_and_b32 v31, 0xffff0000, v111
    v_fmac_f32 v16, v24, v41
    v_fmac_f32 v17, v25, v41
    v_fmac_f32 v18, v26, v41
    v_fmac_f32 v19, v27, v41
    v_fmac_f32 v20, v28, v41
    v_fmac_f32 v21, v29, v41
    v_fmac_f32 v22, v30, v41
    v_fmac_f32 v23, v31, v41
    v_lshlrev_b32 v24, 16, v112
    v_and_b32 v25, 0xffff0000, v112
    v_lshlrev_b32 v26, 16, v113
    v_and_b32 v27, 0xffff0000, v113
    v_lshlrev_b32 v28, 16, v114
    v_and_b32 v29, 0xffff0000, v114
    v_lshlrev_b32 v30, 16, v115
    v_and_b32 v31, 0xffff0000, v115
    v_fmac_f32 v16, v24, v42
    v_fmac_f32 v17, v25, v42
    v_fmac_f32 v18, v26, v42
    v_fmac_f32 v19, v27, v42
    v_fmac_f32 v20, v28, v42
    v_fmac_f32 v21, v29, v42
    v_fmac_f32 v22, v30, v42
    v_fmac_f32 v23, v31, v42
    v_lshlrev_b32 v24, 16, v116
    v_and_b32 v25, 0xffff0000, v116
    v_lshlrev_b32 v26, 16, v117
    v_and_b32 v27, 0xffff0000, v117
    v_lshlrev_b32 v28, 16, v118
    v_and_b32 v29, 0xffff0000, v118
    v_lshlrev_b32 v30, 16, v119
    v_and_b32 v31, 0xffff0000, v119
    v_fmac_f32 v16, v24, v43
    v_fmac_f32 v17, v25, v43
    v_fmac_f32 v18, v26, v43
    v_fmac_f32 v19, v27, v43
    v_fmac_f32 v20, v28, v43
    v_fmac_f32 v21, v29, v43
    v_fmac_f32 v22, v30, v43
    v_fmac_f32 v23, v31, v43
    v_lshlrev_b32 v24, 16, v120
    v_and_b32 v25, 0xffff0000, v120
    v_lshlrev_b32 v26, 16, v121
    v_and_b32 v27, 0xffff0000, v121
    v_lshlrev_b32 v28, 16, v122
    v_and_b32 v29, 0xffff0000, v122
    v_lshlrev_b32 v30, 16, v123
    v_and_b32 v31, 0xffff0000, v123
    v_fmac_f32 v16, v24, v44
    v_fmac_f32 v17, v25, v44
    v_fmac_f32 v18, v26, v44
    v_fmac_f32 v19, v27, v44
    v_fmac_f32 v20, v28, v44
    v_fmac_f32 v21, v29, v44
    v_fmac_f32 v22, v30, v44
    v_fmac_f32 v23, v31, v44
    v_lshlrev_b32 v24, 16, v124
    v_and_b32 v25, 0xffff0000, v124
    v_lshlrev_b32 v26, 16, v125
    v_and_b32 v27, 0xffff0000, v125
    v_lshlrev_b32 v28, 16, v126
    v_and_b32 v29, 0xffff0000, v126
    v_lshlrev_b32 v30, 16, v127
    v_and_b32 v31, 0xffff0000, v127
    v_fmac_f32 v16, v24, v45
    v_fmac_f32 v17, v25, v45
    v_fmac_f32 v18, v26, v45
    v_fmac_f32 v19, v27, v45
    v_fmac_f32 v20, v28, v45
    v_fmac_f32 v21, v29, v45
    v_fmac_f32 v22, v30, v45
    v_fmac_f32 v23, v31, v45
    v_lshlrev_b32 v24, 16, v128
    v_and_b32 v25, 0xffff0000, v128
    v_lshlrev_b32 v26, 16, v129
    v_and_b32 v27, 0xffff0000, v129
    v_lshlrev_b32 v28, 16, v130
    v_and_b32 v29, 0xffff0000, v130
    v_lshlrev_b32 v30, 16, v131
    v_and_b32 v31, 0xffff0000, v131
    v_fmac_f32 v16, v24, v46
    v_fmac_f32 v17, v25, v46
    v_fmac_f32 v18, v26, v46
    v_fmac_f32 v19, v27, v46
    v_fmac_f32 v20, v28, v46
    v_fmac_f32 v21, v29, v46
    v_fmac_f32 v22, v30, v46
    v_fmac_f32 v23, v31, v46
    s_nop 1
    v_permlane32_swap_b32 v16, v20
    v_permlane32_swap_b32 v17, v21
    v_permlane32_swap_b32 v18, v22
    v_permlane32_swap_b32 v19, v23
    s_nop 1
    v_add_f32 v16, v16, v20
    v_add_f32 v17, v17, v21
    v_add_f32 v18, v18, v22
    v_add_f32 v19, v19, v23
    s_nop 1
    v_permlane16_swap_b32 v16, v18
    v_permlane16_swap_b32 v17, v19
    s_nop 1
    v_add_f32 v16, v16, v18
    v_add_f32 v17, v17, v19
    s_nop 1
    v_add_f32_dpp v16, v16, v16 row_ror:8 row_mask:0xf bank_mask:0xf
    v_add_f32_dpp v17, v17, v17 row_ror:8 row_mask:0xf bank_mask:0xf
    v_lshrrev_b32 v2, 4, v0
    v_and_b32 v3, 7, v0
    v_lshlrev_b32 v2, 3, v2
    v_lshl_add_u32 v2, v3, 5, v2
    s_lshl_b32 s25, s4, 8
    s_add_u32 s25, s25, 135168
    v_add_u32 v2, s25, v2
    s_mov_b32 exec_lo, 0x00ff00ff
    s_mov_b32 exec_hi, 0x00ff00ff
    ds_write_b64 v2, v[16:17]
    s_mov_b64 exec, -1
    v_mov_b32 v1, 5
    s_mov_b64 exec, 1
    ds_write_b32 v9, v1 offset:320
    s_mov_b64 exec, -1
    s_cmp_lg_u32 s4, 1
    s_cbranch_scc1 L_noy
    v_lshlrev_b32 v2, 2, v0
    v_add_u32 v3, 135168, v2
L_w17:
    ds_read_b32 v1, v8 offset:320
    s_waitcnt lgkmcnt(0)
    v_cmp_gt_i32 vcc, 5, v1
    s_cbranch_vccz L_wd18
    s_branch L_w17
L_wd18:
    ds_read2st64_b32 v[16:17], v3 offset0:0 offset1:1
    ds_read2st64_b32 v[18:19], v3 offset0:2 offset1:3
    ds_read2st64_b32 v[20:21], v3 offset0:4 offset1:5
    ds_read2st64_b32 v[22:23], v3 offset0:6 offset1:7
    v_bfe_u32 v1, v0, 0, 2
    v_lshlrev_b32 v1, 3, v1
    v_bfe_u32 v1, s84, v1, 8
    v_mov_b32 v3, 0xffffff00
    s_waitcnt lgkmcnt(0)
    v_add_f32 v16, v16, v17
    v_add_f32 v16, v16, v18
    v_add_f32 v16, v16, v19
    v_add_f32 v16, v16, v20
    v_add_f32 v16, v16, v21
    v_add_f32 v16, v16, v22
    v_add_f32 v16, v16, v23
    v_and_or_b32 v16, v16, v3, v1
    buffer_store_dword v16, v2, s[16:19], 0 offen offset:2048 sc1
L_noy:
    s_mov_b32 s12, s42
    s_mov_b32 s13, s43
    s_mov_b32 s14, 3670016
    s_mov_b32 s15, 0x20000
    v_lshrrev_b32 v2, 5, v0
    v_and_b32 v3, 31, v0
    v_mul_u32_u24 v2, 3584, v2
    v_lshl_add_u32 v2, v3, 4, v2
    v_cmp_gt_u32 vcc, 24, v3
    s_lshr_b32 s24, s6, 1
    s_lshl_b32 s24, s24, 3
    s_add_u32 s24, s24, s4
    s_mul_i32 s24, s24, 28672
    v_mov_b32 v3, 0x40000000
    v_cndmask_b32 v38, v3, v2, vcc
    v_mov_b32 v39, v2
    s_mov_b32 s62, s24
    v_mov_b32 v16, 0
    v_mov_b32 v17, 0
    v_mov_b32 v18, 0
    v_mov_b32 v19, 0
    v_mov_b32 v20, 0
    v_mov_b32 v21, 0
    v_mov_b32 v22, 0
    v_mov_b32 v23, 0
    s_mul_i32 s60, s4, 5
    s_lshr_b32 s60, s60, 3
    s_add_u32 s60, s60, 68
    s_mov_b32 s27, 0
    s_mov_b32 s63, 0
L_v_loop:
    s_add_u32 s28, s28, 1
    v_add_u32 v2, s27, v11
    v_add_u32 v3, s27, v12
    ds_read_b128 v[32:35], v13
L_w19:
    ds_read_b32 v1, v8 offset:0
    s_waitcnt lgkmcnt(0)
    v_cmp_gt_i32 vcc, s28, v1
    s_cbranch_vccz L_wd20
    s_branch L_w19
L_wd20:
    ds_read_b64_tr_b16 v[24:25], v2
    ds_read_b64_tr_b16 v[26:27], v2 offset:8192
    ds_read_b64_tr_b16 v[28:29], v3
    ds_read_b64_tr_b16 v[30:31], v3 offset:8192
    v_mov_b32 v1, s28
    v_add_u32 v13, 64, v13
    s_add_u32 s27, s27, 16384
    s_and_b32 s27, s27, 131071
    s_mov_b64 exec, 1
    ds_write_b32 v9, v1 offset:256
    s_mov_b64 exec, -1
    s_waitcnt lgkmcnt(3)
    v_mfma_f32_16x16x32_bf16 v[16:19], v[24:27], v[32:35], v[16:19]
    s_waitcnt lgkmcnt(1)
    v_mfma_f32_16x16x32_bf16 v[20:23], v[28:31], v[32:35], v[20:23]
    s_cmp_lg_u32 s28, s60
    s_cbranch_scc1 L_v_loop
    s_cmp_lg_u32 s28, 126
    s_cbranch_scc1 L_vev
    v_and_b32 v1, 1, v0
    v_lshlrev_b32 v1, 4, v1
    v_mov_b32 v24, 0xffff
    v_lshlrev_b32 v24, v1, v24
    v_bfe_u32 v1, v0, 2, 2
    v_cmp_eq_u32 vcc, 0, v1
    s_nop 1
    v_cndmask_b32 v4, 0, v24, vcc
    v_cmp_eq_u32 vcc, 1, v1
    s_nop 1
    v_cndmask_b32 v5, 0, v24, vcc
    v_cmp_eq_u32 vcc, 2, v1
    s_nop 1
    v_cndmask_b32 v6, 0, v24, vcc
    v_cmp_eq_u32 vcc, 3, v1
    s_nop 1
    v_cndmask_b32 v7, 0, v24, vcc
    s_lshr_b32 s25, s4, 2
    s_mul_i32 s28, s25, 1
    s_add_u32 s28, s28, 127
    s_mul_i32 s25, s25, 16128
    s_add_u32 s27, s27, s25
    v_add_u32 v2, s27, v11
    v_add_u32 v3, s27, v12
    ds_read_b128 v[32:35], v13
    ds_read_b128 v[36:39], v13 offset:64
    s_cmp_gt_u32 s4, 3
    s_cbranch_scc1 L_lb1
L_w21:
    ds_read_b32 v1, v8 offset:0
    s_waitcnt lgkmcnt(0)
    v_cmp_gt_i32 vcc, s28, v1
    s_cbranch_vccz L_wd22
    s_branch L_w21
L_wd22:
    s_branch L_lb2
L_lb1:
    s_barrier
L_lb2:
    ds_read_b64_tr_b16 v[24:25], v2 offset:0
    ds_read_b64_tr_b16 v[26:27], v2 offset:8192
    ds_read_b64_tr_b16 v[28:29], v3 offset:0
    ds_read_b64_tr_b16 v[30:31], v3 offset:8192
    ds_read_b64_tr_b16 v[8:9], v2 offset:256
    ds_read_b64_tr_b16 v[10:11], v2 offset:8448
    ds_read_b64_tr_b16 v[12:13], v3 offset:256
    ds_read_b64_tr_b16 v[14:15], v3 offset:8448
    s_lshl_b32 s25, s4, 11
    s_add_u32 s25, s25, 135168
    v_bfe_i32 v1, v0, 1, 1
    v_and_b32 v1, 0xaaaaaaaa, v1
    v_or_b32 v1, 0x44444444, v1
    s_waitcnt lgkmcnt(6)
    v_mfma_f32_16x16x32_bf16 v[16:19], v[24:27], v[32:35], v[16:19]
    s_waitcnt lgkmcnt(4)
    v_mfma_f32_16x16x32_bf16 v[20:23], v[28:31], v[32:35], v[20:23]
    s_waitcnt lgkmcnt(2)
    v_mfma_f32_16x16x32_bf16 v[16:19], v[8:11], v[36:39], v[16:19]
    s_waitcnt lgkmcnt(0)
    v_mfma_f32_16x16x32_bf16 v[20:23], v[12:15], v[36:39], v[20:23]
    v_mov_b32 v24, 0
    v_mov_b32 v25, 0
    v_mov_b32 v26, 0
    v_mov_b32 v27, 0
    v_mov_b32 v28, 0
    v_mov_b32 v29, 0
    v_mov_b32 v30, 0
    v_mov_b32 v31, 0
    v_cvt_pk_bf16_f32 v16, v16, v16
    v_and_b32 v32, v4, v16
    v_and_b32 v33, v5, v16
    v_and_b32 v34, v6, v16
    v_and_b32 v35, v7, v16
    v_cvt_pk_bf16_f32 v17, v17, v17
    v_cvt_pk_bf16_f32 v18, v18, v18
    v_smfmac_f32_16x16x64_bf16 v[24:27], v[32:35], v[40:47], v1
    v_and_b32 v36, v4, v17
    v_and_b32 v37, v5, v17
    v_and_b32 v38, v6, v17
    v_and_b32 v39, v7, v17
    v_smfmac_f32_16x16x64_bf16 v[28:31], v[32:35], v[48:55], v1
    v_cvt_pk_bf16_f32 v19, v19, v19
    v_and_b32 v2, 15, v0
    v_smfmac_f32_16x16x64_bf16 v[24:27], v[36:39], v[56:63], v1
    v_and_b32 v32, v4, v18
    v_and_b32 v33, v5, v18
    v_and_b32 v34, v6, v18
    v_and_b32 v35, v7, v18
    v_smfmac_f32_16x16x64_bf16 v[28:31], v[36:39], v[64:71], v1
    v_cvt_pk_bf16_f32 v20, v20, v20
    v_lshl_add_u32 v2, v2, 5, s25
    v_smfmac_f32_16x16x64_bf16 v[24:27], v[32:35], v[72:79], v1
    v_and_b32 v36, v4, v19
    v_and_b32 v37, v5, v19
    v_and_b32 v38, v6, v19
    v_and_b32 v39, v7, v19
    v_smfmac_f32_16x16x64_bf16 v[28:31], v[32:35], v[80:87], v1
    v_cvt_pk_bf16_f32 v21, v21, v21
    v_bfe_u32 v3, v0, 4, 1
    v_smfmac_f32_16x16x64_bf16 v[24:27], v[36:39], v[88:95], v1
    v_and_b32 v32, v4, v20
    v_and_b32 v33, v5, v20
    v_and_b32 v34, v6, v20
    v_and_b32 v35, v7, v20
    v_smfmac_f32_16x16x64_bf16 v[28:31], v[36:39], v[96:103], v1
    v_cvt_pk_bf16_f32 v22, v22, v22
    v_lshl_add_u32 v2, v3, 4, v2
    v_smfmac_f32_16x16x64_bf16 v[24:27], v[32:35], v[104:111], v1
    v_and_b32 v36, v4, v21
    v_and_b32 v37, v5, v21
    v_and_b32 v38, v6, v21
    v_and_b32 v39, v7, v21
    v_smfmac_f32_16x16x64_bf16 v[28:31], v[32:35], v[112:119], v1
    v_cvt_pk_bf16_f32 v23, v23, v23
    v_bfe_u32 v3, v0, 5, 1
    v_smfmac_f32_16x16x64_bf16 v[24:27], v[36:39], v[120:127], v1
    v_and_b32 v32, v4, v22
    v_and_b32 v33, v5, v22
    v_and_b32 v34, v6, v22
    v_and_b32 v35, v7, v22
    v_smfmac_f32_16x16x64_bf16 v[28:31], v[36:39], v[128:135], v1
    v_lshl_add_u32 v2, v3, 9, v2
    v_smfmac_f32_16x16x64_bf16 v[24:27], v[32:35], v[136:143], v1
    v_and_b32 v36, v4, v23
    v_and_b32 v37, v5, v23
    v_and_b32 v38, v6, v23
    v_and_b32 v39, v7, v23
    v_smfmac_f32_16x16x64_bf16 v[28:31], v[32:35], v[144:151], v1
    s_cmp_gt_u32 s4, 2
    v_smfmac_f32_16x16x64_bf16 v[24:27], v[36:39], v[152:159], v1
    v_smfmac_f32_16x16x64_bf16 v[28:31], v[36:39], v[160:167], v1
    s_subb_u32 s25, s4, 0
    s_lshl_b32 s24, s25, 8
    s_add_u32 s24, s24, 135168
    v_lshl_add_u32 v3, v0, 2, s24
    s_nop 9
    ds_write_b128 v2, v[24:27]
    ds_write_b128 v2, v[28:31] offset:1024
    s_cmp_gt_u32 s4, 3
    s_cbranch_scc1 L_lb3
    s_barrier
L_lb3:
    v_bfe_u32 v1, v0, 0, 2
    v_lshlrev_b32 v1, 3, v1
    v_bfe_u32 v1, s84, v1, 8
    s_lshl_b32 s25, s25, 8
    v_lshlrev_b32 v2, 2, v0
    s_cmp_eq_u32 s4, 2
    s_waitcnt lgkmcnt(0)
    s_barrier
    s_cbranch_scc1 L_final
    ds_read2st64_b32 v[16:17], v3 offset0:0 offset1:8
    ds_read2st64_b32 v[18:19], v3 offset0:16 offset1:24
    ds_read2st64_b32 v[20:21], v3 offset0:32 offset1:40
    ds_read2st64_b32 v[22:23], v3 offset0:48 offset1:56
    s_waitcnt lgkmcnt(2)
    v_add_f32 v16, v16, v17
    v_add_f32 v18, v18, v19
    s_waitcnt lgkmcnt(0)
    v_add_f32 v20, v20, v21
    v_add_f32 v22, v22, v23
    v_add_f32 v16, v16, v18
    v_add_f32 v20, v20, v22
    v_mov_b32 v3, 0xffffff00
    v_add_f32 v16, v16, v20
    v_mul_f32 v16, s58, v16
    v_and_or_b32 v16, v16, v3, v1
    buffer_store_dword v16, v2, s[16:19], s25 offen sc1
    s_branch L_exit
L_vev:
    s_add_u32 s60, s60, 5
    s_add_u32 s63, s63, 1
    s_cmp_eq_u32 s63, 1
    s_cbranch_scc1 L_wo0
    s_cmp_eq_u32 s63, 2
    s_cbranch_scc1 L_wo1
    s_cmp_eq_u32 s63, 3
    s_cbranch_scc1 L_wo2
    s_cmp_eq_u32 s63, 4
    s_cbranch_scc1 L_wo3
    s_cmp_eq_u32 s63, 5
    s_cbranch_scc1 L_wo4
    s_cmp_eq_u32 s63, 6
    s_cbranch_scc1 L_wo5
    s_cmp_eq_u32 s63, 7
    s_cbranch_scc1 L_wo6
    s_cmp_eq_u32 s63, 8
    s_cbranch_scc1 L_wo7
    s_branch L_vev2
L_wo0:
    s_add_u32 s24, s62, 7168
    buffer_load_dwordx4 v[40:43], v39, s[12:15], s62 offen offset:0
    buffer_load_dwordx4 v[44:47], v39, s[12:15], s24 offen offset:0
    buffer_load_dwordx4 v[48:51], v38, s[12:15], s62 offen offset:512
    buffer_load_dwordx4 v[52:55], v38, s[12:15], s24 offen offset:512
    s_branch L_v_loop
L_wo1:
    s_add_u32 s24, s62, 7168
    buffer_load_dwordx4 v[56:59], v39, s[12:15], s62 offen offset:896
    buffer_load_dwordx4 v[60:63], v39, s[12:15], s24 offen offset:896
    buffer_load_dwordx4 v[64:67], v38, s[12:15], s62 offen offset:1408
    buffer_load_dwordx4 v[68:71], v38, s[12:15], s24 offen offset:1408
    s_branch L_v_loop
L_wo2:
    s_add_u32 s24, s62, 7168
    buffer_load_dwordx4 v[72:75], v39, s[12:15], s62 offen offset:1792
    buffer_load_dwordx4 v[76:79], v39, s[12:15], s24 offen offset:1792
    buffer_load_dwordx4 v[80:83], v38, s[12:15], s62 offen offset:2304
    buffer_load_dwordx4 v[84:87], v38, s[12:15], s24 offen offset:2304
    s_branch L_v_loop
L_wo3:
    s_add_u32 s24, s62, 7168
    buffer_load_dwordx4 v[88:91], v39, s[12:15], s62 offen offset:2688
    buffer_load_dwordx4 v[92:95], v39, s[12:15], s24 offen offset:2688
    buffer_load_dwordx4 v[96:99], v38, s[12:15], s62 offen offset:3200
    buffer_load_dwordx4 v[100:103], v38, s[12:15], s24 offen offset:3200
    s_add_u32 s62, s62, 14336
    s_branch L_v_loop
L_wo4:
    s_add_u32 s24, s62, 7168
    buffer_load_dwordx4 v[104:107], v39, s[12:15], s62 offen offset:0
    buffer_load_dwordx4 v[108:111], v39, s[12:15], s24 offen offset:0
    buffer_load_dwordx4 v[112:115], v38, s[12:15], s62 offen offset:512
    buffer_load_dwordx4 v[116:119], v38, s[12:15], s24 offen offset:512
    s_branch L_v_loop
L_wo5:
    s_add_u32 s24, s62, 7168
    buffer_load_dwordx4 v[120:123], v39, s[12:15], s62 offen offset:896
    buffer_load_dwordx4 v[124:127], v39, s[12:15], s24 offen offset:896
    buffer_load_dwordx4 v[128:131], v38, s[12:15], s62 offen offset:1408
    buffer_load_dwordx4 v[132:135], v38, s[12:15], s24 offen offset:1408
    s_branch L_v_loop
L_wo6:
    s_add_u32 s24, s62, 7168
    buffer_load_dwordx4 v[136:139], v39, s[12:15], s62 offen offset:1792
    buffer_load_dwordx4 v[140:143], v39, s[12:15], s24 offen offset:1792
    buffer_load_dwordx4 v[144:147], v38, s[12:15], s62 offen offset:2304
    buffer_load_dwordx4 v[148:151], v38, s[12:15], s24 offen offset:2304
    s_branch L_v_loop
L_wo7:
    s_add_u32 s24, s62, 7168
    buffer_load_dwordx4 v[152:155], v39, s[12:15], s62 offen offset:2688
    buffer_load_dwordx4 v[156:159], v39, s[12:15], s24 offen offset:2688
    buffer_load_dwordx4 v[160:163], v38, s[12:15], s62 offen offset:3200
    buffer_load_dwordx4 v[164:167], v38, s[12:15], s24 offen offset:3200
    s_branch L_v_loop
L_vev2:
    s_mov_b32 s60, 126
    s_xor_b32 s24, s7, 1
    s_mul_i32 s24, s24, 2304
    v_mov_b32 v36, 263936
L_mlp:
    buffer_load_dwordx4 v[28:31], v36, s[20:23], s24 offen sc1
    s_waitcnt vmcnt(0)
    v_xor_b32 v28, s80, v28
    v_xor_b32 v29, s81, v29
    v_xor_b32 v30, s82, v30
    v_xor_b32 v31, s83, v31
    v_or3_b32 v1, v28, v29, v30
    v_or_b32 v1, v1, v31
    v_and_b32 v1, 0xff, v1
    v_cmp_ne_u32 vcc, 0, v1
    s_cbranch_vccnz L_mlp
    v_mov_b32 v2, v28
    v_mov_b32 v3, v29
    v_max_f32 v24, s56, v2
    v_sub_f32 v25, s56, v24
    v_sub_f32 v2, v2, v24
    v_mul_f32 v25, s26, v25
    v_mul_f32 v2, s26, v2
    v_exp_f32 v25, v25
    v_exp_f32 v2, v2
    s_nop 0
    v_mul_f32 v3, v3, v2
    v_fma_f32 v3, v25, s57, v3
    v_rcp_f32 v3, v3
    s_nop 0
    v_mul_f32 v15, v25, v3
    s_nop 0
    v_readfirstlane_b32 s58, v15
    s_cmp_lg_u32 s4, 2
    s_cbranch_scc1 L_v_loop
    s_cmp_ge_u32 s6, 28
    s_cbranch_scc1 L_v_loop
    s_branch L_gy
L_final:
    s_cmp_ge_u32 s6, 28
    s_cbranch_scc1 L_exit
    v_and_b32 v1, 63, v0
    v_lshlrev_b32 v1, 2, v1
    v_add_u32 v1, 152064, v1
    ds_read_b32 v14, v1
    v_bfe_u32 v2, v0, 2, 4
    v_and_b32 v3, 3, v0
    v_mul_u32_u24 v2, 2304, v2
    v_lshl_add_u32 v2, v3, 4, v2
    s_mul_i32 s24, s5, 73728
    s_add_u32 s24, s24, 262144
    s_lshl_b32 s25, s6, 6
    s_add_u32 s24, s24, s25
    s_add_u32 s25, s24, 36864
    s_mov_b64 s[86:87], 0
L_gp:
    buffer_load_dwordx4 v[24:27], v2, s[20:23], s24 offen sc1
    buffer_load_dwordx4 v[28:31], v2, s[20:23], s25 offen sc1
    s_waitcnt vmcnt(0)
    v_xor_b32 v24, s80, v24
    v_xor_b32 v25, s81, v25
    v_xor_b32 v26, s82, v26
    v_xor_b32 v27, s83, v27
    v_xor_b32 v28, s80, v28
    v_xor_b32 v29, s81, v29
    v_xor_b32 v30, s82, v30
    v_xor_b32 v31, s83, v31
    v_or3_b32 v1, v24, v25, v26
    v_or3_b32 v1, v1, v27, v28
    v_or3_b32 v1, v1, v29, v30
    v_or_b32 v1, v1, v31
    s_nop 1
    v_or_b32_dpp v1, v1, v1 quad_perm:[1,0,3,2] row_mask:0xf bank_mask:0xf
    s_nop 1
    v_or_b32_dpp v1, v1, v1 quad_perm:[2,3,0,1] row_mask:0xf bank_mask:0xf
    v_and_b32 v1, 0xff, v1
    v_cmp_ne_u32 vcc, 0, v1
    s_and_b64 exec, exec, vcc
    s_cbranch_scc1 L_gp
    s_mov_b64 exec, -1
    v_add_f32 v24, v24, v28
    v_add_f32 v25, v25, v29
    v_add_f32 v26, v26, v30
    v_add_f32 v27, v27, v31
    s_nop 0
    v_permlane32_swap_b32 v24, v25
    v_permlane32_swap_b32 v26, v27
    s_nop 0
    v_add_f32 v24, v24, v25
    v_add_f32 v26, v26, v27
    s_nop 1
    v_permlane16_swap_b32 v24, v26
    s_nop 1
    v_add_f32 v24, v24, v26
    s_nop 1
    v_add_f32_dpp v24, v24, v24 row_ror:4 row_mask:0xf bank_mask:0xf
    s_nop 1
    v_add_f32_dpp v24, v24, v24 row_ror:8 row_mask:0xf bank_mask:0xf
    v_cvt_pk_bf16_f32 v24, v24, v24
    v_and_b32 v24, 0xffff0000, v24
    s_waitcnt lgkmcnt(0)
    v_mul_f32 v24, v24, v14
    v_cvt_pk_bf16_f32 v24, v24, v24
    v_and_b32 v24, 0xffff0000, v24
    v_and_b32 v1, 0xffff0000, v0
    v_and_b32 v2, 0x0000ffc0, v0
    v_add_f32 v24, v24, v1
    v_lshrrev_b32 v2, 5, v2
    v_cvt_pk_bf16_f32 v24, v24, v24
    buffer_store_short v24, v2, s[8:11], 0 offen
    s_cmp_lg_u32 s2, 0
    s_cbranch_scc1 L_exit
    v_mov_b32 v1, s84
    v_mov_b32 v2, 0
    s_mov_b64 exec, 1
    buffer_store_dword v1, v2, s[20:23], 0 offen sc1
    s_mov_b64 exec, -1
L_exit:
L_end:
    s_endpgm
L_gy:
    v_and_b32 v1, 3, v0
    v_bfe_u32 v2, v0, 4, 1
    v_bfe_u32 v3, v0, 5, 1
    v_lshl_add_u32 v2, v2, 1, v3
    v_lshl_add_u32 v3, v1, 2, v2
    v_lshlrev_b32 v2, 3, v2
    v_bfe_u32 v28, s84, v2, 8
    v_lshlrev_b32 v2, 2, v3
    s_and_b32 s24, s7, 0xfc
    s_mul_i32 s24, s24, 2304
    s_and_b32 s25, s6, 3
    s_lshl_b32 s25, s25, 6
    s_add_u32 s24, s24, s25
    s_add_u32 s24, s24, 264192
    s_add_u32 s25, s24, 4608
L_yp:
    buffer_load_dword v24, v2, s[20:23], s24 offen offset:0 sc1
    buffer_load_dword v25, v2, s[20:23], s24 offen offset:2304 sc1
    buffer_load_dword v26, v2, s[20:23], s25 offen offset:0 sc1
    buffer_load_dword v27, v2, s[20:23], s25 offen offset:2304 sc1
    s_waitcnt vmcnt(0)
    v_xor_b32 v24, v28, v24
    v_xor_b32 v25, v28, v25
    v_xor_b32 v26, v28, v26
    v_xor_b32 v27, v28, v27
    v_or3_b32 v1, v24, v25, v26
    v_or_b32 v1, v1, v27
    v_and_b32 v1, 0xff, v1
    v_cmp_ne_u32 vcc, 0, v1
    s_cbranch_vccnz L_yp
    v_add_f32 v24, v24, v25
    v_add_f32 v26, v26, v27
    v_add_f32 v24, v24, v26
    v_cvt_pk_bf16_f32 v24, v24, v24
    v_and_b32 v24, 0xffff0000, v24
    v_mul_f32 v1, 3216550459, v24
    v_exp_f32 v1, v1
    s_nop 0
    v_add_f32 v1, 1.0, v1
    v_rcp_f32 v1, v1
    s_nop 0
    v_mul_f32 v14, v24, v1
    v_cvt_pk_bf16_f32 v14, v14, v14
    v_and_b32 v14, 0xffff0000, v14
    v_lshlrev_b32 v1, 2, v0
    v_add_u32 v1, 152064, v1
    ds_write_b32 v1, v14
    s_lshl_b32 s24, s6, 4
    v_add_u32 v3, s24, v3
    v_and_b32 v1, 15, v0
    v_cmp_gt_u32 vcc, 4, v1
    v_mov_b32 v1, 1023
    s_nop 0
    v_cndmask_b32 v3, v1, v3, vcc
    v_lshlrev_b32 v2, 1, v3
    s_mul_i32 s24, s5, 896
    s_add_u32 s8, s32, s24
    s_addc_u32 s9, s33, 0
    s_mov_b32 s10, 896
    s_mov_b32 s11, 0x20000
    buffer_load_ushort v1, v2, s[8:11], 0 offen nt
    s_add_u32 s8, s50, s24
    s_addc_u32 s9, s51, 0
    v_lshl_add_u32 v0, v3, 6, v0
    s_waitcnt vmcnt(0)
    v_lshl_add_u32 v0, v1, 16, v0
    s_branch L_v_loop
.section .rodata,"a"
.p2align 6
.amdhsa_kernel recurrent_scan__mha_block_cached__geglu_ffn__decode_kernel
  .amdhsa_next_free_vgpr 168
  .amdhsa_next_free_sgpr 96
  .amdhsa_accum_offset 168
  .amdhsa_group_segment_fixed_size 0
  .amdhsa_kernarg_size 96
  .amdhsa_user_sgpr_count 2
  .amdhsa_user_sgpr_kernarg_segment_ptr 1
  .amdhsa_system_sgpr_workgroup_id_x 1
.end_amdhsa_kernel
```
